```python
import torch

def _softmax(x, axis=-1):
    return torch.softmax(x, dim=axis)

def _gelu(x):
    return torch.nn.functional.gelu(x, approximate='tanh')

def _silu(x):
    return torch.nn.functional.silu(x)

def _sigmoid(x):
    return torch.sigmoid(x)

def _layernorm(x, axis=-1, eps=1e-05):
    m = x.mean(dim=axis, keepdim=True)
    v = x.var(dim=axis, keepdim=True, unbiased=False)
    return (x - m) / torch.sqrt(v + eps)

def _scatter_add(tgt, idx, src, axis=0):
    return tgt.clone().index_add_(axis, idx, src)

def _segment_sum(src, seg, n):
    out = torch.zeros((n,) + src.shape[1:], dtype=src.dtype)
    return out.index_add_(0, seg, src)

def _pad(x, pw):
    flat = tuple((v for pair in reversed(pw) for v in pair))
    return torch.nn.functional.pad(x, flat)
kernel_name = 'standalone__molecular_angular_painn__graph'

def setup_inputs():

    _w = lambda a: (lambda t: t.to(torch.bfloat16) if t.is_floating_point() else t)(torch.as_tensor(a))
    N, deg, D = (25000, 32, 64)
    n_rbf = max(16, 4)
    E = N * deg
    cutoff = 5.0
    freqs = (torch.arange(1, n_rbf + 1) * torch.pi / cutoff).to(float)
    return {'sv': _w((lambda *s: torch.randn(*s, dtype=torch.bfloat16) * 0.4)(N, 4, D) * 0.3), 'pos': _w((lambda *s: torch.randn(*s, dtype=torch.bfloat16) * 1.6)(N, 3) * 1.2), 'src': _w((lambda lo, hi, *s: torch.randint(lo, hi, s))(0, N, E).to(torch.int64)), 'dst': _w((lambda lo, hi, *s: torch.randint(lo, hi, s))(0, N, E).to(torch.int64)), 'freqs': _w(freqs), 'w_phi1': _w((lambda *s: torch.randn(*s, dtype=torch.bfloat16) * 3.2)(D, D) / D ** 0.5), 'w_phi2': _w((lambda *s: torch.randn(*s, dtype=torch.bfloat16) * 1.6)(D, 3 * D) / D ** 0.5), 'w_rbf': _w((lambda *s: torch.randn(*s, dtype=torch.bfloat16) * 1.6)(n_rbf, 3 * D) / n_rbf ** 0.5)}

def reference(sv, pos, src, dst, freqs, w_phi1, w_phi2, w_rbf):
    N, _, D = sv.shape
    E = src.shape[0]
    PI, cutoff = (3.141592653589793, 5.0)
    s, v = (sv[:, 0, :].clone(), sv[:, 1:, :].clone())
    r_vec = pos[src] - pos[dst]
    d = torch.sqrt((r_vec * r_vec).sum(-1) + 1e-08)
    r_hat = r_vec / d[:, None]
    rbf = torch.sin(d[:, None] * freqs[None, :]) / d[:, None]
    fcut = 0.5 * (torch.cos(PI * d / cutoff) + 1.0)
    fcut = torch.where(d < cutoff, fcut, 0.0 * d)
    Wf = rbf @ w_rbf * fcut[:, None]
    phi = (_silu(s @ w_phi1) @ w_phi2)[src]
    m = phi * Wf
    m_s, m_vv, m_vr = (m[:, :D].clone(), m[:, D:2 * D].clone(), m[:, 2 * D:].clone())
    ds = _segment_sum(m_s, dst, N)
    dv_e = m_vv[:, None, :] * v[src] + m_vr[:, None, :] * r_hat[:, :, None]
    dv = _segment_sum(dv_e.reshape(E, 3 * D), dst, N).reshape(N, 3, D)
    return sv + torch.concatenate([ds[:, None, :], dv], axis=1)
```

```asm
; @launch grid=(256,1,1) block=(512,1,1) lds=163840
.amdgcn_target "amdgcn-amd-amdhsa--gfx950"
.text
.globl standalone__molecular_angular_painn__graph_kernel
.p2align 8
.type standalone__molecular_angular_painn__graph_kernel,@function
standalone__molecular_angular_painn__graph_kernel:
    s_cmp_ge_u32 s2, 256
    s_cbranch_scc1 K_END
    s_memrealtime s[26:27]
    s_load_dwordx16 s[4:19], s[0:1], 0
    s_load_dwordx4 s[20:23], s[0:1], 64
    s_load_dwordx2 s[24:25], s[0:1], 80
    v_lshrrev_b32 v1, 6, v0
    v_and_b32 v2, 63, v0
    v_readfirstlane_b32 s48, v1
    v_lshlrev_b32 v236, 2, v0
    v_mov_b32 v237, 0
    ds_write_b32 v236, v237 offset:0
    ds_write_b32 v236, v237 offset:2048
    v_and_b32 v239, 0xfc, v236
    ds_write_b32 v239, v237 offset:4096
    v_lshrrev_b32 v3, 4, v2
    v_and_b32 v4, 15, v0
    v_lshlrev_b32 v1, 4, v2
    s_mul_i32 s64, s2, 12544
    s_mul_i32 s65, s2, 3136
    s_sub_u32 s65, 800000, s65
    v_lshlrev_b32 v5, 4, v0
    v_add_u32 v6, 7168, v236
    s_and_b32 s100, s2, 7
    s_lshl_b32 s100, s100, 5
    s_lshr_b32 s3, s2, 3
    s_or_b32 s100, s100, s3
    s_mul_i32 s66, s100, 98
    s_mul_i32 s67, s48, 14
    s_add_u32 s66, s66, s67
    s_lshl_b32 s67, s66, 9
    s_mov_b32 s50, 0
    s_mov_b32 s98, 32
    s_mov_b32 s99, 0
    s_mov_b32 s101, 1
    s_and_b32 s68, s48, 1
    s_sub_u32 s69, s48, 2
    s_lshr_b32 s69, s69, 1
    s_lshl_b32 s69, s69, 7
    s_lshl_b32 s68, s68, 5
    s_movk_i32 s70, 384
    s_cmp_lt_u32 s48, 2
    s_cselect_b32 s70, 128, s70
    s_cselect_b32 s69, 0, s69
    v_lshrrev_b32 v12, 3, v2
    v_and_b32 v13, 7, v2
    v_lshl_add_u32 v239, v12, 2, s68
    v_mul_lo_u32 v239, v239, s70
    v_lshl_add_u32 v239, v13, 4, v239
    v_lshlrev_b32 v8, 9, v12
    v_lshl_add_u32 v8, v13, 4, v8
    v_mov_b32 v238, 1
    s_waitcnt lgkmcnt(0)
    s_cselect_b32 s32, s14, s16
    s_cselect_b32 s33, s15, s17
    s_lshl_b32 s34, s70, 6
    s_and_b32 s33, s33, 0xffff
    s_mov_b32 s35, 0x20000
    s_cmp_eq_u32 s48, 7
    s_cbranch_scc1 K_COMM
    buffer_load_dwordx4 v[176:179], v239, s[32:35], s69 offen
    s_add_u32 s69, s69, s70
    buffer_load_dwordx4 v[180:183], v239, s[32:35], s69 offen
    s_add_u32 s69, s69, s70
    buffer_load_dwordx4 v[184:187], v239, s[32:35], s69 offen
    s_add_u32 s69, s69, s70
    buffer_load_dwordx4 v[188:191], v239, s[32:35], s69 offen
    s_mov_b32 s84, s4
    s_and_b32 s85, s5, 0xffff
    s_mov_b32 s86, 0xc35000
    s_mov_b32 s87, 0x20000
    s_mul_i32 s89, s48, 1792
    s_add_u32 s89, s89, 118528
    s_mov_b32 m0, s89
    s_add_u32 s3, s67, 3072
    buffer_load_dwordx4 v8, s[84:87], s67 offen lds
    s_mov_b32 s72, -1
    s_mov_b32 s73, 0xffff
    s_mov_b64 exec, s[72:73]
    buffer_load_dwordx4 v8, s[84:87], s3 offen offset:1024 lds
    s_mov_b64 exec, -1
    s_mov_b32 s40, s8
    s_and_b32 s41, s9, 0xffff
    s_mov_b32 s42, 0x30d400
    s_mov_b32 s43, 0x20000
    s_mov_b32 s44, s10
    s_and_b32 s45, s11, 0xffff
    s_mov_b32 s46, 0x30d400
    s_mov_b32 s47, 0x20000
    s_barrier
    buffer_load_dwordx4 v[160:163], v5, s[44:47], s64 offen
    buffer_load_dword v164, v6, s[44:47], s64 offen offset:0
    buffer_load_dword v165, v6, s[44:47], s64 offen offset:1792
    buffer_load_dword v166, v6, s[44:47], s64 offen offset:3584
    buffer_load_dwordx4 v[152:155], v5, s[40:43], s64 offen
    buffer_load_dword v156, v6, s[40:43], s64 offen offset:0
    buffer_load_dword v157, v6, s[40:43], s64 offen offset:1792
    buffer_load_dword v158, v6, s[40:43], s64 offen offset:3584
    s_mov_b32 s36, s6
    s_and_b32 s37, s7, 0xffff
    s_mov_b32 s38, 0x249f0
    s_mov_b32 s39, 0x20000
    s_mov_b32 s28, s24
    s_and_b32 s29, s25, 0xffff
    s_mov_b32 s30, 0xf50000
    s_mov_b32 s31, 0x20000
    s_add_u32 s32, s24, 0x1000000
    s_addc_u32 s33, s25, 0
    s_and_b32 s33, s33, 0xffff
    s_mov_b32 s34, 0x310000
    s_mov_b32 s35, 0x20000
    s_add_u32 s80, s24, 0x1400000
    s_addc_u32 s81, s25, 0
    s_and_b32 s81, s81, 0xffff
    s_mov_b32 s82, 0x80000
    s_mov_b32 s83, 0x20000
    s_mov_b32 s44, 0x05040100
    s_mov_b32 s45, 0x07060302
    s_movk_i32 s88, -98
    v_cmp_gt_u32 s[74:75], s65, v236
    v_add_u32 v240, 1792, v0
    v_cmp_gt_u32 s[76:77], s65, v240
    v_add_u32 v240, 2240, v0
    v_cmp_gt_u32 s[78:79], s65, v240
    v_add_u32 v240, 2688, v0
    v_cmp_gt_u32 s[90:91], s65, v240
    v_lshlrev_b32 v7, 11, v3
    v_lshl_add_u32 v7, v4, 2, v7
    v_lshl_add_u32 v9, v4, 7, s89
    v_lshl_add_u32 v9, v3, 4, v9
    s_mov_b64 exec, -1
    s_waitcnt vmcnt(10)
    v_perm_b32 v192, v180, v176, s44
    v_perm_b32 v193, v188, v184, s44
    v_perm_b32 v194, v180, v176, s45
    v_perm_b32 v195, v188, v184, s45
    v_perm_b32 v196, v181, v177, s44
    v_perm_b32 v197, v189, v185, s44
    v_perm_b32 v198, v181, v177, s45
    v_perm_b32 v199, v189, v185, s45
    v_perm_b32 v200, v182, v178, s44
    v_perm_b32 v201, v190, v186, s44
    v_perm_b32 v202, v182, v178, s45
    v_perm_b32 v203, v190, v186, s45
    v_perm_b32 v204, v183, v179, s44
    v_perm_b32 v205, v191, v187, s44
    v_perm_b32 v206, v183, v179, s45
    v_perm_b32 v207, v191, v187, s45
    s_lshl_b32 s3, s48, 12
    s_add_u32 s3, s3, 131072
    v_lshrrev_b32 v239, 2, v13
    v_lshl_add_u32 v239, v239, 11, s3
    v_lshl_add_u32 v239, v3, 8, v239
    v_and_b32 v240, 3, v13
    v_lshl_add_u32 v239, v240, 6, v239
    v_and_b32 v240, 1, v12
    v_lshl_add_u32 v239, v240, 3, v239
    ds_write_b64 v239, v[192:193] offset:0
    ds_write_b64 v239, v[194:195] offset:1024
    ds_write_b64 v239, v[196:197] offset:16
    ds_write_b64 v239, v[198:199] offset:1040
    ds_write_b64 v239, v[200:201] offset:32
    ds_write_b64 v239, v[202:203] offset:1056
    ds_write_b64 v239, v[204:205] offset:48
    ds_write_b64 v239, v[206:207] offset:1072
    s_mov_b64 exec, 1
    ds_add_u32 v237, v238 offset:4312
    s_mov_b64 exec, -1
    s_waitcnt vmcnt(0)
    ds_read_b128 v[40:43], v9
    ds_read_b128 v[44:47], v9 offset:64
    s_mov_b64 exec, s[74:75]
    v_mul_u32_u24 v239, 42800, v160
    v_lshrrev_b32 v240, 9, v152
    v_lshrrev_b32 v239, 22, v239
    v_lshl_or_b32 v152, v240, 23, v152
    v_mad_i32_i24 v240, v239, s88, v160
    v_lshlrev_b32 v160, 2, v239
    v_lshl_or_b32 v152, v240, 16, v152
    ds_add_rtn_u32 v168, v160, v238 offset:2048
    v_lshl_or_b32 v152, v240, 29, v152
    v_mul_u32_u24 v239, 42800, v161
    v_lshrrev_b32 v240, 9, v153
    v_lshrrev_b32 v239, 22, v239
    v_lshl_or_b32 v153, v240, 23, v153
    v_mad_i32_i24 v240, v239, s88, v161
    v_lshlrev_b32 v161, 2, v239
    v_lshl_or_b32 v153, v240, 16, v153
    ds_add_rtn_u32 v169, v161, v238 offset:2048
    v_lshl_or_b32 v153, v240, 29, v153
    v_mul_u32_u24 v239, 42800, v162
    v_lshrrev_b32 v240, 9, v154
    v_lshrrev_b32 v239, 22, v239
    v_lshl_or_b32 v154, v240, 23, v154
    v_mad_i32_i24 v240, v239, s88, v162
    v_lshlrev_b32 v162, 2, v239
    v_lshl_or_b32 v154, v240, 16, v154
    ds_add_rtn_u32 v170, v162, v238 offset:2048
    v_lshl_or_b32 v154, v240, 29, v154
    v_mul_u32_u24 v239, 42800, v163
    v_lshrrev_b32 v240, 9, v155
    v_lshrrev_b32 v239, 22, v239
    v_lshl_or_b32 v155, v240, 23, v155
    v_mad_i32_i24 v240, v239, s88, v163
    v_lshlrev_b32 v163, 2, v239
    v_lshl_or_b32 v155, v240, 16, v155
    ds_add_rtn_u32 v171, v163, v238 offset:2048
    v_lshl_or_b32 v155, v240, 29, v155
    s_mov_b64 exec, s[76:77]
    v_mul_u32_u24 v239, 42800, v164
    v_lshrrev_b32 v240, 9, v156
    v_lshrrev_b32 v239, 22, v239
    v_lshl_or_b32 v156, v240, 23, v156
    v_mad_i32_i24 v240, v239, s88, v164
    v_lshlrev_b32 v164, 2, v239
    v_lshl_or_b32 v156, v240, 16, v156
    ds_add_rtn_u32 v172, v164, v238 offset:2048
    v_lshl_or_b32 v156, v240, 29, v156
    s_mov_b64 exec, s[78:79]
    v_mul_u32_u24 v239, 42800, v165
    v_lshrrev_b32 v240, 9, v157
    v_lshrrev_b32 v239, 22, v239
    v_lshl_or_b32 v157, v240, 23, v157
    v_mad_i32_i24 v240, v239, s88, v165
    v_lshlrev_b32 v165, 2, v239
    v_lshl_or_b32 v157, v240, 16, v157
    ds_add_rtn_u32 v173, v165, v238 offset:2048
    v_lshl_or_b32 v157, v240, 29, v157
    s_mov_b64 exec, s[90:91]
    v_mul_u32_u24 v239, 42800, v166
    v_lshrrev_b32 v240, 9, v158
    v_lshrrev_b32 v239, 22, v239
    v_lshl_or_b32 v158, v240, 23, v158
    v_mad_i32_i24 v240, v239, s88, v166
    v_lshlrev_b32 v166, 2, v239
    v_lshl_or_b32 v158, v240, 16, v158
    ds_add_rtn_u32 v174, v166, v238 offset:2048
    v_lshl_or_b32 v158, v240, 29, v158
    s_mov_b64 exec, -1
    s_mov_b64 exec, 1
    ds_add_u32 v237, v238 offset:4304
    s_mov_b64 exec, -1
    buffer_load_dword v48, v7, s[84:87], s67 offen offset:128
    buffer_load_dword v49, v7, s[84:87], s67 offen offset:192
    buffer_load_dword v50, v7, s[84:87], s67 offen offset:256
    buffer_load_dword v51, v7, s[84:87], s67 offen offset:320
    buffer_load_dword v52, v7, s[84:87], s67 offen offset:384
    buffer_load_dword v53, v7, s[84:87], s67 offen offset:448
    buffer_load_dword v54, v7, s[84:87], s67 offen offset:640
    buffer_load_dword v55, v7, s[84:87], s67 offen offset:704
    buffer_load_dword v56, v7, s[84:87], s67 offen offset:768
    buffer_load_dword v57, v7, s[84:87], s67 offen offset:832
    buffer_load_dword v58, v7, s[84:87], s67 offen offset:896
    buffer_load_dword v59, v7, s[84:87], s67 offen offset:960
    s_mov_b64 exec, -1
    v_add_u32 v5, 131072, v1
    s_nop 1
K_S2:
    ds_read_b32 v239, v237 offset:4312
    s_waitcnt lgkmcnt(0)
    v_readfirstlane_b32 s3, v239
    s_nop 0
    s_cmp_lt_u32 s3, 8
    s_cbranch_scc1 K_S2
    ds_read_b128 v[8:11], v5 offset:0
    ds_read_b128 v[12:15], v5 offset:1024
    ds_read_b128 v[16:19], v5 offset:2048
    ds_read_b128 v[20:23], v5 offset:3072
    ds_read_b128 v[24:27], v5 offset:4096
    ds_read_b128 v[28:31], v5 offset:5120
    ds_read_b128 v[32:35], v5 offset:6144
    ds_read_b128 v[36:39], v5 offset:7168
K_S0:
    ds_read_b32 v239, v237 offset:4304
    s_waitcnt lgkmcnt(0)
    v_readfirstlane_b32 s3, v239
    s_nop 0
    s_cmp_lt_u32 s3, 7
    s_cbranch_scc1 K_S0
    ds_read_b128 v[200:203], v1 offset:2048
    s_waitcnt lgkmcnt(0)
    v_add_u32 v205, v200, v201
    v_add_u32 v206, v205, v202
    v_add_u32 v207, v206, v203
    v_mov_b32 v204, v207
    s_nop 1
    v_add_u32_dpp v204, v204, v204 row_shr:1 row_mask:0xf bank_mask:0xf
    s_nop 1
    v_add_u32_dpp v204, v204, v204 row_shr:2 row_mask:0xf bank_mask:0xf
    s_nop 1
    v_add_u32_dpp v204, v204, v204 row_shr:4 row_mask:0xf bank_mask:0xf
    s_nop 1
    v_add_u32_dpp v204, v204, v204 row_shr:8 row_mask:0xf bank_mask:0xf
    s_nop 1
    v_add_u32_dpp v204, v204, v204 row_bcast:15 row_mask:0xa bank_mask:0xf
    s_nop 1
    v_add_u32_dpp v204, v204, v204 row_bcast:31 row_mask:0xc bank_mask:0xf
    v_sub_u32 v208, v204, v207
    v_add_u32 v209, v208, v200
    v_add_u32 v210, v208, v205
    v_add_u32 v211, v208, v206
    ds_write_b128 v1, v[208:211] offset:3072
    s_mov_b64 exec, s[74:75]
    ds_read_b32 v160, v160 offset:3072
    ds_read_b32 v161, v161 offset:3072
    ds_read_b32 v162, v162 offset:3072
    ds_read_b32 v163, v163 offset:3072
    s_mov_b64 exec, s[76:77]
    ds_read_b32 v164, v164 offset:3072
    s_mov_b64 exec, s[78:79]
    ds_read_b32 v165, v165 offset:3072
    s_mov_b64 exec, s[90:91]
    ds_read_b32 v166, v166 offset:3072
    s_mov_b64 exec, -1
    s_mov_b32 s71, 29632
    s_waitcnt lgkmcnt(0)
    s_mov_b64 exec, s[74:75]
    v_add3_u32 v160, v160, v168, s71
    v_lshlrev_b32 v160, 2, v160
    ds_write_b32 v160, v152
    v_add3_u32 v161, v161, v169, s71
    v_lshlrev_b32 v161, 2, v161
    ds_write_b32 v161, v153
    v_add3_u32 v162, v162, v170, s71
    v_lshlrev_b32 v162, 2, v162
    ds_write_b32 v162, v154
    v_add3_u32 v163, v163, v171, s71
    v_lshlrev_b32 v163, 2, v163
    ds_write_b32 v163, v155
    s_mov_b64 exec, s[76:77]
    v_add3_u32 v164, v164, v172, s71
    v_lshlrev_b32 v164, 2, v164
    ds_write_b32 v164, v156
    s_mov_b64 exec, s[78:79]
    v_add3_u32 v165, v165, v173, s71
    v_lshlrev_b32 v165, 2, v165
    ds_write_b32 v165, v157
    s_mov_b64 exec, s[90:91]
    v_add3_u32 v166, v166, v174, s71
    v_lshlrev_b32 v166, 2, v166
    ds_write_b32 v166, v158
    s_mov_b64 exec, -1
    s_mov_b64 exec, 1
    ds_add_u32 v237, v238 offset:4308
    s_mov_b64 exec, -1
    s_waitcnt lgkmcnt(4)
    v_mfma_f32_16x16x32_bf16 v[96:99], v[8:11], v[40:43], 0
    v_mfma_f32_16x16x32_bf16 v[100:103], v[12:15], v[40:43], 0
    v_mfma_f32_16x16x32_bf16 v[104:107], v[16:19], v[40:43], 0
    v_mfma_f32_16x16x32_bf16 v[108:111], v[20:23], v[40:43], 0
    s_waitcnt lgkmcnt(0)
    v_mfma_f32_16x16x32_bf16 v[96:99], v[24:27], v[44:47], v[96:99]
    v_mfma_f32_16x16x32_bf16 v[100:103], v[28:31], v[44:47], v[100:103]
    v_mfma_f32_16x16x32_bf16 v[104:107], v[32:35], v[44:47], v[104:107]
    v_mfma_f32_16x16x32_bf16 v[108:111], v[36:39], v[44:47], v[108:111]
    s_mov_b64 exec, s[72:73]
    buffer_load_dword v60, v7, s[84:87], s67 offen offset:1152
    buffer_load_dword v61, v7, s[84:87], s67 offen offset:1216
    buffer_load_dword v62, v7, s[84:87], s67 offen offset:1280
    buffer_load_dword v63, v7, s[84:87], s67 offen offset:1344
    buffer_load_dword v64, v7, s[84:87], s67 offen offset:1408
    buffer_load_dword v65, v7, s[84:87], s67 offen offset:1472
    s_mov_b64 exec, s[72:73]
    buffer_load_dword v66, v7, s[84:87], s67 offen offset:1664
    buffer_load_dword v67, v7, s[84:87], s67 offen offset:1728
    buffer_load_dword v68, v7, s[84:87], s67 offen offset:1792
    buffer_load_dword v69, v7, s[84:87], s67 offen offset:1856
    buffer_load_dword v70, v7, s[84:87], s67 offen offset:1920
    buffer_load_dword v71, v7, s[84:87], s67 offen offset:1984
    s_mov_b64 exec, -1
    ds_read_b128 v[8:11], v5 offset:16384
    ds_read_b128 v[12:15], v5 offset:17408
    ds_read_b128 v[16:19], v5 offset:18432
    ds_read_b128 v[20:23], v5 offset:19456
    ds_read_b128 v[24:27], v5 offset:20480
    ds_read_b128 v[28:31], v5 offset:21504
    ds_read_b128 v[32:35], v5 offset:22528
    ds_read_b128 v[36:39], v5 offset:23552
    s_mov_b32 s68, 0xbfb8aa3b
    v_cvt_pk_bf16_f32 v96, 0, v96
    v_cvt_pk_bf16_f32 v97, 0, v97
    v_cvt_pk_bf16_f32 v98, 0, v98
    v_cvt_pk_bf16_f32 v99, 0, v99
    v_cvt_pk_bf16_f32 v100, 0, v100
    v_cvt_pk_bf16_f32 v101, 0, v101
    v_cvt_pk_bf16_f32 v102, 0, v102
    v_cvt_pk_bf16_f32 v103, 0, v103
    v_cvt_pk_bf16_f32 v104, 0, v104
    v_cvt_pk_bf16_f32 v105, 0, v105
    v_cvt_pk_bf16_f32 v106, 0, v106
    v_cvt_pk_bf16_f32 v107, 0, v107
    v_cvt_pk_bf16_f32 v108, 0, v108
    v_cvt_pk_bf16_f32 v109, 0, v109
    v_cvt_pk_bf16_f32 v110, 0, v110
    v_cvt_pk_bf16_f32 v111, 0, v111
    v_mul_f32 v112, s68, v96
    v_mul_f32 v113, s68, v97
    v_mul_f32 v114, s68, v98
    v_mul_f32 v115, s68, v99
    v_mul_f32 v116, s68, v100
    v_mul_f32 v117, s68, v101
    v_mul_f32 v118, s68, v102
    v_mul_f32 v119, s68, v103
    v_mul_f32 v120, s68, v104
    v_mul_f32 v121, s68, v105
    v_mul_f32 v122, s68, v106
    v_mul_f32 v123, s68, v107
    v_mul_f32 v124, s68, v108
    v_mul_f32 v125, s68, v109
    v_mul_f32 v126, s68, v110
    v_mul_f32 v127, s68, v111
    v_exp_f32 v112, v112
    v_exp_f32 v113, v113
    v_exp_f32 v114, v114
    v_exp_f32 v115, v115
    v_exp_f32 v116, v116
    v_exp_f32 v117, v117
    v_exp_f32 v118, v118
    v_exp_f32 v119, v119
    v_exp_f32 v120, v120
    v_exp_f32 v121, v121
    v_exp_f32 v122, v122
    v_exp_f32 v123, v123
    v_exp_f32 v124, v124
    v_exp_f32 v125, v125
    v_exp_f32 v126, v126
    v_exp_f32 v127, v127
    v_add_f32 v112, 1.0, v112
    v_add_f32 v113, 1.0, v113
    v_add_f32 v114, 1.0, v114
    v_add_f32 v115, 1.0, v115
    v_add_f32 v116, 1.0, v116
    v_add_f32 v117, 1.0, v117
    v_add_f32 v118, 1.0, v118
    v_add_f32 v119, 1.0, v119
    v_add_f32 v120, 1.0, v120
    v_add_f32 v121, 1.0, v121
    v_add_f32 v122, 1.0, v122
    v_add_f32 v123, 1.0, v123
    v_add_f32 v124, 1.0, v124
    v_add_f32 v125, 1.0, v125
    v_add_f32 v126, 1.0, v126
    v_add_f32 v127, 1.0, v127
    v_rcp_f32 v112, v112
    v_rcp_f32 v113, v113
    v_rcp_f32 v114, v114
    v_rcp_f32 v115, v115
    v_rcp_f32 v116, v116
    v_rcp_f32 v117, v117
    v_rcp_f32 v118, v118
    v_rcp_f32 v119, v119
    v_rcp_f32 v120, v120
    v_rcp_f32 v121, v121
    v_rcp_f32 v122, v122
    v_rcp_f32 v123, v123
    v_rcp_f32 v124, v124
    v_rcp_f32 v125, v125
    v_rcp_f32 v126, v126
    v_rcp_f32 v127, v127
    v_mul_f32 v112, v112, v96
    v_mul_f32 v113, v113, v97
    v_mul_f32 v114, v114, v98
    v_mul_f32 v115, v115, v99
    v_mul_f32 v116, v116, v100
    v_mul_f32 v117, v117, v101
    v_mul_f32 v118, v118, v102
    v_mul_f32 v119, v119, v103
    v_mul_f32 v120, v120, v104
    v_mul_f32 v121, v121, v105
    v_mul_f32 v122, v122, v106
    v_mul_f32 v123, v123, v107
    v_mul_f32 v124, v124, v108
    v_mul_f32 v125, v125, v109
    v_mul_f32 v126, v126, v110
    v_mul_f32 v127, v127, v111
    v_cvt_pk_bf16_f32 v72, v112, v116
    v_cvt_pk_bf16_f32 v73, v113, v117
    v_cvt_pk_bf16_f32 v74, v114, v118
    v_cvt_pk_bf16_f32 v75, v115, v119
    v_cvt_pk_bf16_f32 v76, v120, v124
    v_cvt_pk_bf16_f32 v77, v121, v125
    v_cvt_pk_bf16_f32 v78, v122, v126
    v_cvt_pk_bf16_f32 v79, v123, v127
    s_waitcnt lgkmcnt(4)
    v_mfma_f32_16x16x32_bf16 v[96:99], v[72:75], v[8:11], 0
    v_mfma_f32_16x16x32_bf16 v[100:103], v[72:75], v[12:15], 0
    v_mfma_f32_16x16x32_bf16 v[104:107], v[72:75], v[16:19], 0
    v_mfma_f32_16x16x32_bf16 v[108:111], v[72:75], v[20:23], 0
    s_waitcnt lgkmcnt(0)
    v_mfma_f32_16x16x32_bf16 v[96:99], v[76:79], v[24:27], v[96:99]
    v_mfma_f32_16x16x32_bf16 v[100:103], v[76:79], v[28:31], v[100:103]
    v_mfma_f32_16x16x32_bf16 v[104:107], v[76:79], v[32:35], v[104:107]
    v_mfma_f32_16x16x32_bf16 v[108:111], v[76:79], v[36:39], v[108:111]
    ds_read_b128 v[8:11], v5 offset:24576
    ds_read_b128 v[12:15], v5 offset:25600
    ds_read_b128 v[16:19], v5 offset:26624
    ds_read_b128 v[20:23], v5 offset:27648
    ds_read_b128 v[24:27], v5 offset:28672
    ds_read_b128 v[28:31], v5 offset:29696
    ds_read_b128 v[32:35], v5 offset:30720
    ds_read_b128 v[36:39], v5 offset:31744
    s_waitcnt lgkmcnt(4)
    v_mfma_f32_16x16x32_bf16 v[112:115], v[72:75], v[8:11], 0
    v_mfma_f32_16x16x32_bf16 v[116:119], v[72:75], v[12:15], 0
    v_mfma_f32_16x16x32_bf16 v[120:123], v[72:75], v[16:19], 0
    v_mfma_f32_16x16x32_bf16 v[124:127], v[72:75], v[20:23], 0
    s_waitcnt lgkmcnt(0)
    v_mfma_f32_16x16x32_bf16 v[112:115], v[76:79], v[24:27], v[112:115]
    v_mfma_f32_16x16x32_bf16 v[116:119], v[76:79], v[28:31], v[116:119]
    v_mfma_f32_16x16x32_bf16 v[120:123], v[76:79], v[32:35], v[120:123]
    v_mfma_f32_16x16x32_bf16 v[124:127], v[76:79], v[36:39], v[124:127]
    ds_read_b128 v[8:11], v5 offset:8192
    ds_read_b128 v[12:15], v5 offset:9216
    ds_read_b128 v[16:19], v5 offset:10240
    ds_read_b128 v[20:23], v5 offset:11264
    ds_read_b128 v[24:27], v5 offset:12288
    ds_read_b128 v[28:31], v5 offset:13312
    ds_read_b128 v[32:35], v5 offset:14336
    ds_read_b128 v[36:39], v5 offset:15360
    s_waitcnt lgkmcnt(4)
    v_mfma_f32_16x16x32_bf16 v[80:83], v[72:75], v[8:11], 0
    v_mfma_f32_16x16x32_bf16 v[84:87], v[72:75], v[12:15], 0
    v_mfma_f32_16x16x32_bf16 v[88:91], v[72:75], v[16:19], 0
    v_mfma_f32_16x16x32_bf16 v[92:95], v[72:75], v[20:23], 0
    s_waitcnt lgkmcnt(0)
    v_mfma_f32_16x16x32_bf16 v[80:83], v[76:79], v[24:27], v[80:83]
    v_mfma_f32_16x16x32_bf16 v[84:87], v[76:79], v[28:31], v[84:87]
    v_mfma_f32_16x16x32_bf16 v[88:91], v[76:79], v[32:35], v[88:91]
    v_mfma_f32_16x16x32_bf16 v[92:95], v[76:79], v[36:39], v[92:95]
    s_mov_b64 exec, 1
    ds_add_u32 v237, v238 offset:4316
    s_mov_b64 exec, -1
    s_lshl_b32 s3, s48, 10
    s_add_u32 s3, s3, 110592
    buffer_load_dwordx4 v[216:219], v1, s[36:39], s3 offen
    s_add_u32 s3, s3, 8192
    buffer_load_dwordx4 v[220:223], v1, s[36:39], s3 offen
    s_add_u32 s3, s3, 8192
    buffer_load_dwordx4 v[224:227], v1, s[36:39], s3 offen
    s_add_u32 s3, s3, 8192
    buffer_load_dwordx4 v[228:231], v1, s[36:39], s3 offen
    s_add_u32 s3, s3, 8192
    buffer_load_dwordx4 v[232:235], v1, s[36:39], s3 offen
    s_mov_b64 exec, 1
    ds_add_u32 v237, v238 offset:4328
    s_mov_b64 exec, -1
    s_mul_i32 s12, s66, 640
    v_mul_u32_u24 v7, 2560, v3
    v_lshl_add_u32 v6, v4, 4, v7
    v_lshl_add_u32 v7, v4, 2, v7
    v_mov_b32 v5, 0x7f000000
    v_cndmask_b32 v190, v5, v6, s[72:73]
    v_cndmask_b32 v191, v5, v7, s[72:73]
    s_mov_b32 s8, s24
    s_and_b32 s9, s25, 0xffff
    s_mov_b32 s10, 0xf50000
    s_mov_b32 s11, 0x20000
    s_mov_b32 s68, 0xffff0000
    s_mov_b32 s69, 0x3f805c00
    s_mov_b32 s70, 0x8000
    v_cvt_pk_bf16_f32 v96, 0, v96
    v_cvt_pk_bf16_f32 v97, 0, v97
    v_cvt_pk_bf16_f32 v98, 0, v98
    v_cvt_pk_bf16_f32 v99, 0, v99
    v_cvt_pk_bf16_f32 v100, 0, v100
    v_cvt_pk_bf16_f32 v101, 0, v101
    v_cvt_pk_bf16_f32 v102, 0, v102
    v_cvt_pk_bf16_f32 v103, 0, v103
    v_cvt_pk_bf16_f32 v104, 0, v104
    v_cvt_pk_bf16_f32 v105, 0, v105
    v_cvt_pk_bf16_f32 v106, 0, v106
    v_cvt_pk_bf16_f32 v107, 0, v107
    v_cvt_pk_bf16_f32 v108, 0, v108
    v_cvt_pk_bf16_f32 v109, 0, v109
    v_cvt_pk_bf16_f32 v110, 0, v110
    v_cvt_pk_bf16_f32 v111, 0, v111
    v_mov_b32 v72, 0xd800001
    v_mul_f32 v96, s69, v96
    v_mul_f32 v97, s69, v97
    v_mul_f32 v98, s69, v98
    v_mul_f32 v99, s69, v99
    v_mul_f32 v100, s69, v100
    v_mul_f32 v101, s69, v101
    v_mul_f32 v102, s69, v102
    v_mul_f32 v103, s69, v103
    v_mul_f32 v104, s69, v104
    v_mul_f32 v105, s69, v105
    v_mul_f32 v106, s69, v106
    v_mul_f32 v107, s69, v107
    v_mul_f32 v108, s69, v108
    v_mul_f32 v109, s69, v109
    v_mul_f32 v110, s69, v110
    v_mul_f32 v111, s69, v111
    v_cvt_pk_bf16_f32 v112, 0, v112
    v_cvt_pk_bf16_f32 v113, 0, v113
    v_cvt_pk_bf16_f32 v114, 0, v114
    v_cvt_pk_bf16_f32 v115, 0, v115
    v_cvt_pk_bf16_f32 v116, 0, v116
    v_cvt_pk_bf16_f32 v117, 0, v117
    v_cvt_pk_bf16_f32 v118, 0, v118
    v_cvt_pk_bf16_f32 v119, 0, v119
    v_cvt_pk_bf16_f32 v120, 0, v120
    v_cvt_pk_bf16_f32 v121, 0, v121
    v_cvt_pk_bf16_f32 v122, 0, v122
    v_cvt_pk_bf16_f32 v123, 0, v123
    v_cvt_pk_bf16_f32 v124, 0, v124
    v_cvt_pk_bf16_f32 v125, 0, v125
    v_cvt_pk_bf16_f32 v126, 0, v126
    v_cvt_pk_bf16_f32 v127, 0, v127
    v_fma_f32 v112, v112, s69, v72
    v_fma_f32 v113, v113, s69, v72
    v_fma_f32 v114, v114, s69, v72
    v_fma_f32 v115, v115, s69, v72
    v_fma_f32 v116, v116, s69, v72
    v_fma_f32 v117, v117, s69, v72
    v_fma_f32 v118, v118, s69, v72
    v_fma_f32 v119, v119, s69, v72
    v_fma_f32 v120, v120, s69, v72
    v_fma_f32 v121, v121, s69, v72
    v_fma_f32 v122, v122, s69, v72
    v_fma_f32 v123, v123, s69, v72
    v_fma_f32 v124, v124, s69, v72
    v_fma_f32 v125, v125, s69, v72
    v_fma_f32 v126, v126, s69, v72
    v_fma_f32 v127, v127, s69, v72
    v_add_u32 v112, s70, v112
    v_add_u32 v113, s70, v113
    v_add_u32 v114, s70, v114
    v_add_u32 v115, s70, v115
    v_add_u32 v116, s70, v116
    v_add_u32 v117, s70, v117
    v_add_u32 v118, s70, v118
    v_add_u32 v119, s70, v119
    v_add_u32 v120, s70, v120
    v_add_u32 v121, s70, v121
    v_add_u32 v122, s70, v122
    v_add_u32 v123, s70, v123
    v_add_u32 v124, s70, v124
    v_add_u32 v125, s70, v125
    v_add_u32 v126, s70, v126
    v_add_u32 v127, s70, v127
    v_cvt_pk_bf16_f32 v80, 0, v80
    v_cvt_pk_bf16_f32 v81, 0, v81
    v_cvt_pk_bf16_f32 v82, 0, v82
    v_cvt_pk_bf16_f32 v83, 0, v83
    v_cvt_pk_bf16_f32 v84, 0, v84
    v_cvt_pk_bf16_f32 v85, 0, v85
    v_cvt_pk_bf16_f32 v86, 0, v86
    v_cvt_pk_bf16_f32 v87, 0, v87
    v_cvt_pk_bf16_f32 v88, 0, v88
    v_cvt_pk_bf16_f32 v89, 0, v89
    v_cvt_pk_bf16_f32 v90, 0, v90
    v_cvt_pk_bf16_f32 v91, 0, v91
    v_cvt_pk_bf16_f32 v92, 0, v92
    v_cvt_pk_bf16_f32 v93, 0, v93
    v_cvt_pk_bf16_f32 v94, 0, v94
    v_cvt_pk_bf16_f32 v95, 0, v95
    v_fma_f32 v80, v80, s69, v72
    v_fma_f32 v81, v81, s69, v72
    v_fma_f32 v82, v82, s69, v72
    v_fma_f32 v83, v83, s69, v72
    v_fma_f32 v84, v84, s69, v72
    v_fma_f32 v85, v85, s69, v72
    v_fma_f32 v86, v86, s69, v72
    v_fma_f32 v87, v87, s69, v72
    v_fma_f32 v88, v88, s69, v72
    v_fma_f32 v89, v89, s69, v72
    v_fma_f32 v90, v90, s69, v72
    v_fma_f32 v91, v91, s69, v72
    v_fma_f32 v92, v92, s69, v72
    v_fma_f32 v93, v93, s69, v72
    v_fma_f32 v94, v94, s69, v72
    v_fma_f32 v95, v95, s69, v72
    v_add_u32 v80, s70, v80
    v_add_u32 v81, s70, v81
    v_add_u32 v82, s70, v82
    v_add_u32 v83, s70, v83
    v_add_u32 v84, s70, v84
    v_add_u32 v85, s70, v85
    v_add_u32 v86, s70, v86
    v_add_u32 v87, s70, v87
    v_add_u32 v88, s70, v88
    v_add_u32 v89, s70, v89
    v_add_u32 v90, s70, v90
    v_add_u32 v91, s70, v91
    v_add_u32 v92, s70, v92
    v_add_u32 v93, s70, v93
    v_add_u32 v94, s70, v94
    v_add_u32 v95, s70, v95
    s_nop 1
K_S4:
    ds_read_b32 v239, v237 offset:4320
    s_waitcnt lgkmcnt(0)
    v_readfirstlane_b32 s3, v239
    s_nop 0
    s_cmp_lt_u32 s3, 1
    s_cbranch_scc1 K_S4
    ds_read_b64 v[240:241], v237 offset:4288
    s_waitcnt lgkmcnt(0)
    v_readfirstlane_b32 s26, v240
    v_readfirstlane_b32 s27, v241
    s_waitcnt vmcnt(23)
    v_lshlrev_b32 v32, 16, v48
    v_and_b32 v33, s68, v48
    v_lshlrev_b32 v34, 16, v49
    v_and_b32 v35, s68, v49
    v_lshlrev_b32 v36, 16, v50
    v_and_b32 v37, s68, v50
    v_lshlrev_b32 v38, 16, v51
    v_and_b32 v39, s68, v51
    v_lshlrev_b32 v40, 16, v52
    v_and_b32 v41, s68, v52
    v_lshlrev_b32 v42, 16, v53
    v_and_b32 v43, s68, v53
    v_fma_f32 v32, v32, v96, v72
    v_fma_f32 v33, v33, v100, v72
    v_fma_f32 v34, v34, v104, v72
    v_fma_f32 v35, v35, v108, v72
    v_fma_f32 v36, v36, v96, v72
    v_fma_f32 v37, v37, v100, v72
    v_fma_f32 v38, v38, v104, v72
    v_fma_f32 v39, v39, v108, v72
    v_fma_f32 v40, v40, v96, v72
    v_fma_f32 v41, v41, v100, v72
    v_fma_f32 v42, v42, v104, v72
    v_fma_f32 v43, v43, v108, v72
    v_add_u32 v32, s70, v32
    v_add_u32 v33, s70, v33
    v_add_u32 v34, s70, v34
    v_add_u32 v35, s70, v35
    v_add_u32 v36, s70, v36
    v_add_u32 v37, s70, v37
    v_add_u32 v38, s70, v38
    v_add_u32 v39, s70, v39
    v_add_u32 v40, s70, v40
    v_add_u32 v41, s70, v41
    v_add_u32 v42, s70, v42
    v_add_u32 v43, s70, v43
    v_sub_u32_sdwa v33, v33, v32 dst_sel:DWORD dst_unused:UNUSED_PAD src0_sel:DWORD src1_sel:WORD_1
    v_sub_u32_sdwa v36, v36, v33 dst_sel:DWORD dst_unused:UNUSED_PAD src0_sel:DWORD src1_sel:WORD_1
    v_sub_u32_sdwa v37, v37, v36 dst_sel:DWORD dst_unused:UNUSED_PAD src0_sel:DWORD src1_sel:WORD_1
    v_perm_b32 v8, v33, v32, s45
    v_perm_b32 v9, v37, v36, s45
    v_sub_u32_sdwa v41, v41, v40 dst_sel:DWORD dst_unused:UNUSED_PAD src0_sel:DWORD src1_sel:WORD_1
    v_sub_u32_sdwa v112, v112, v41 dst_sel:DWORD dst_unused:UNUSED_PAD src0_sel:DWORD src1_sel:WORD_1
    v_sub_u32_sdwa v116, v116, v112 dst_sel:DWORD dst_unused:UNUSED_PAD src0_sel:DWORD src1_sel:WORD_1
    v_perm_b32 v10, v41, v40, s45
    v_perm_b32 v11, v116, v112, s45
    v_sub_u32_sdwa v35, v35, v34 dst_sel:DWORD dst_unused:UNUSED_PAD src0_sel:DWORD src1_sel:WORD_1
    v_sub_u32_sdwa v38, v38, v35 dst_sel:DWORD dst_unused:UNUSED_PAD src0_sel:DWORD src1_sel:WORD_1
    v_sub_u32_sdwa v39, v39, v38 dst_sel:DWORD dst_unused:UNUSED_PAD src0_sel:DWORD src1_sel:WORD_1
    v_perm_b32 v12, v35, v34, s45
    v_perm_b32 v13, v39, v38, s45
    v_sub_u32_sdwa v43, v43, v42 dst_sel:DWORD dst_unused:UNUSED_PAD src0_sel:DWORD src1_sel:WORD_1
    v_sub_u32_sdwa v120, v120, v43 dst_sel:DWORD dst_unused:UNUSED_PAD src0_sel:DWORD src1_sel:WORD_1
    v_sub_u32_sdwa v124, v124, v120 dst_sel:DWORD dst_unused:UNUSED_PAD src0_sel:DWORD src1_sel:WORD_1
    v_perm_b32 v14, v43, v42, s45
    v_perm_b32 v15, v124, v120, s45
    v_sub_u32_sdwa v84, v84, v80 dst_sel:DWORD dst_unused:UNUSED_PAD src0_sel:DWORD src1_sel:WORD_1
    v_sub_u32_sdwa v88, v88, v84 dst_sel:DWORD dst_unused:UNUSED_PAD src0_sel:DWORD src1_sel:WORD_1
    v_sub_u32_sdwa v92, v92, v88 dst_sel:DWORD dst_unused:UNUSED_PAD src0_sel:DWORD src1_sel:WORD_1
    v_perm_b32 v16, v84, v80, s45
    v_perm_b32 v17, v92, v88, s45
    s_waitcnt vmcnt(17)
    v_lshlrev_b32 v32, 16, v54
    v_and_b32 v33, s68, v54
    v_lshlrev_b32 v34, 16, v55
    v_and_b32 v35, s68, v55
    v_lshlrev_b32 v36, 16, v56
    v_and_b32 v37, s68, v56
    v_lshlrev_b32 v38, 16, v57
    v_and_b32 v39, s68, v57
    v_lshlrev_b32 v40, 16, v58
    v_and_b32 v41, s68, v58
    v_lshlrev_b32 v42, 16, v59
    v_and_b32 v43, s68, v59
    v_fma_f32 v32, v32, v97, v72
    v_fma_f32 v33, v33, v101, v72
    v_fma_f32 v34, v34, v105, v72
    v_fma_f32 v35, v35, v109, v72
    v_fma_f32 v36, v36, v97, v72
    v_fma_f32 v37, v37, v101, v72
    v_fma_f32 v38, v38, v105, v72
    v_fma_f32 v39, v39, v109, v72
    v_fma_f32 v40, v40, v97, v72
    v_fma_f32 v41, v41, v101, v72
    v_fma_f32 v42, v42, v105, v72
    v_fma_f32 v43, v43, v109, v72
    v_add_u32 v32, s70, v32
    v_add_u32 v33, s70, v33
    v_add_u32 v34, s70, v34
    v_add_u32 v35, s70, v35
    v_add_u32 v36, s70, v36
    v_add_u32 v37, s70, v37
    v_add_u32 v38, s70, v38
    v_add_u32 v39, s70, v39
    v_add_u32 v40, s70, v40
    v_add_u32 v41, s70, v41
    v_add_u32 v42, s70, v42
    v_add_u32 v43, s70, v43
    v_sub_u32_sdwa v33, v33, v32 dst_sel:DWORD dst_unused:UNUSED_PAD src0_sel:DWORD src1_sel:WORD_1
    v_sub_u32_sdwa v36, v36, v33 dst_sel:DWORD dst_unused:UNUSED_PAD src0_sel:DWORD src1_sel:WORD_1
    v_sub_u32_sdwa v37, v37, v36 dst_sel:DWORD dst_unused:UNUSED_PAD src0_sel:DWORD src1_sel:WORD_1
    v_perm_b32 v20, v33, v32, s45
    v_perm_b32 v21, v37, v36, s45
    v_sub_u32_sdwa v41, v41, v40 dst_sel:DWORD dst_unused:UNUSED_PAD src0_sel:DWORD src1_sel:WORD_1
    v_sub_u32_sdwa v113, v113, v41 dst_sel:DWORD dst_unused:UNUSED_PAD src0_sel:DWORD src1_sel:WORD_1
    v_sub_u32_sdwa v117, v117, v113 dst_sel:DWORD dst_unused:UNUSED_PAD src0_sel:DWORD src1_sel:WORD_1
    v_perm_b32 v22, v41, v40, s45
    v_perm_b32 v23, v117, v113, s45
    v_sub_u32_sdwa v35, v35, v34 dst_sel:DWORD dst_unused:UNUSED_PAD src0_sel:DWORD src1_sel:WORD_1
    v_sub_u32_sdwa v38, v38, v35 dst_sel:DWORD dst_unused:UNUSED_PAD src0_sel:DWORD src1_sel:WORD_1
    v_sub_u32_sdwa v39, v39, v38 dst_sel:DWORD dst_unused:UNUSED_PAD src0_sel:DWORD src1_sel:WORD_1
    v_perm_b32 v24, v35, v34, s45
    v_perm_b32 v25, v39, v38, s45
    v_sub_u32_sdwa v43, v43, v42 dst_sel:DWORD dst_unused:UNUSED_PAD src0_sel:DWORD src1_sel:WORD_1
    v_sub_u32_sdwa v121, v121, v43 dst_sel:DWORD dst_unused:UNUSED_PAD src0_sel:DWORD src1_sel:WORD_1
    v_sub_u32_sdwa v125, v125, v121 dst_sel:DWORD dst_unused:UNUSED_PAD src0_sel:DWORD src1_sel:WORD_1
    v_perm_b32 v26, v43, v42, s45
    v_perm_b32 v27, v125, v121, s45
    v_sub_u32_sdwa v85, v85, v81 dst_sel:DWORD dst_unused:UNUSED_PAD src0_sel:DWORD src1_sel:WORD_1
    v_sub_u32_sdwa v89, v89, v85 dst_sel:DWORD dst_unused:UNUSED_PAD src0_sel:DWORD src1_sel:WORD_1
    v_sub_u32_sdwa v93, v93, v89 dst_sel:DWORD dst_unused:UNUSED_PAD src0_sel:DWORD src1_sel:WORD_1
    v_perm_b32 v28, v85, v81, s45
    v_perm_b32 v29, v93, v89, s45
    s_nop 1
K_S6:
    ds_read_b32 v239, v237 offset:4328
    s_waitcnt lgkmcnt(0)
    v_readfirstlane_b32 s3, v239
    s_nop 0
    s_cmp_lt_u32 s3, 7
    s_cbranch_scc1 K_S6
    buffer_store_dwordx4 v[8:11], v6, s[8:11], s12 offen offset:0 sc1
    buffer_store_dwordx4 v[12:15], v6, s[8:11], s12 offen offset:256 sc1
    buffer_store_dword v16, v7, s[8:11], s12 offen offset:512 sc1
    buffer_store_dword v17, v7, s[8:11], s12 offen offset:576 sc1
    buffer_store_dwordx4 v[20:23], v6, s[8:11], s12 offen offset:640 sc1
    buffer_store_dwordx4 v[24:27], v6, s[8:11], s12 offen offset:896 sc1
    buffer_store_dword v28, v7, s[8:11], s12 offen offset:1152 sc1
    buffer_store_dword v29, v7, s[8:11], s12 offen offset:1216 sc1
    s_waitcnt vmcnt(19)
    v_lshlrev_b32 v32, 16, v60
    v_and_b32 v33, s68, v60
    v_lshlrev_b32 v34, 16, v61
    v_and_b32 v35, s68, v61
    v_lshlrev_b32 v36, 16, v62
    v_and_b32 v37, s68, v62
    v_lshlrev_b32 v38, 16, v63
    v_and_b32 v39, s68, v63
    v_lshlrev_b32 v40, 16, v64
    v_and_b32 v41, s68, v64
    v_lshlrev_b32 v42, 16, v65
    v_and_b32 v43, s68, v65
    v_fma_f32 v32, v32, v98, v72
    v_fma_f32 v33, v33, v102, v72
    v_fma_f32 v34, v34, v106, v72
    v_fma_f32 v35, v35, v110, v72
    v_fma_f32 v36, v36, v98, v72
    v_fma_f32 v37, v37, v102, v72
    v_fma_f32 v38, v38, v106, v72
    v_fma_f32 v39, v39, v110, v72
    v_fma_f32 v40, v40, v98, v72
    v_fma_f32 v41, v41, v102, v72
    v_fma_f32 v42, v42, v106, v72
    v_fma_f32 v43, v43, v110, v72
    v_add_u32 v32, s70, v32
    v_add_u32 v33, s70, v33
    v_add_u32 v34, s70, v34
    v_add_u32 v35, s70, v35
    v_add_u32 v36, s70, v36
    v_add_u32 v37, s70, v37
    v_add_u32 v38, s70, v38
    v_add_u32 v39, s70, v39
    v_add_u32 v40, s70, v40
    v_add_u32 v41, s70, v41
    v_add_u32 v42, s70, v42
    v_add_u32 v43, s70, v43
    v_sub_u32_sdwa v33, v33, v32 dst_sel:DWORD dst_unused:UNUSED_PAD src0_sel:DWORD src1_sel:WORD_1
    v_sub_u32_sdwa v36, v36, v33 dst_sel:DWORD dst_unused:UNUSED_PAD src0_sel:DWORD src1_sel:WORD_1
    v_sub_u32_sdwa v37, v37, v36 dst_sel:DWORD dst_unused:UNUSED_PAD src0_sel:DWORD src1_sel:WORD_1
    v_perm_b32 v168, v33, v32, s45
    v_perm_b32 v169, v37, v36, s45
    v_sub_u32_sdwa v41, v41, v40 dst_sel:DWORD dst_unused:UNUSED_PAD src0_sel:DWORD src1_sel:WORD_1
    v_sub_u32_sdwa v114, v114, v41 dst_sel:DWORD dst_unused:UNUSED_PAD src0_sel:DWORD src1_sel:WORD_1
    v_sub_u32_sdwa v118, v118, v114 dst_sel:DWORD dst_unused:UNUSED_PAD src0_sel:DWORD src1_sel:WORD_1
    v_perm_b32 v170, v41, v40, s45
    v_perm_b32 v171, v118, v114, s45
    v_sub_u32_sdwa v35, v35, v34 dst_sel:DWORD dst_unused:UNUSED_PAD src0_sel:DWORD src1_sel:WORD_1
    v_sub_u32_sdwa v38, v38, v35 dst_sel:DWORD dst_unused:UNUSED_PAD src0_sel:DWORD src1_sel:WORD_1
    v_sub_u32_sdwa v39, v39, v38 dst_sel:DWORD dst_unused:UNUSED_PAD src0_sel:DWORD src1_sel:WORD_1
    v_perm_b32 v172, v35, v34, s45
    v_perm_b32 v173, v39, v38, s45
    v_sub_u32_sdwa v43, v43, v42 dst_sel:DWORD dst_unused:UNUSED_PAD src0_sel:DWORD src1_sel:WORD_1
    v_sub_u32_sdwa v122, v122, v43 dst_sel:DWORD dst_unused:UNUSED_PAD src0_sel:DWORD src1_sel:WORD_1
    v_sub_u32_sdwa v126, v126, v122 dst_sel:DWORD dst_unused:UNUSED_PAD src0_sel:DWORD src1_sel:WORD_1
    v_perm_b32 v174, v43, v42, s45
    v_perm_b32 v175, v126, v122, s45
    v_sub_u32_sdwa v86, v86, v82 dst_sel:DWORD dst_unused:UNUSED_PAD src0_sel:DWORD src1_sel:WORD_1
    v_sub_u32_sdwa v90, v90, v86 dst_sel:DWORD dst_unused:UNUSED_PAD src0_sel:DWORD src1_sel:WORD_1
    v_sub_u32_sdwa v94, v94, v90 dst_sel:DWORD dst_unused:UNUSED_PAD src0_sel:DWORD src1_sel:WORD_1
    v_perm_b32 v176, v86, v82, s45
    v_perm_b32 v177, v94, v90, s45
    buffer_store_dwordx4 v[168:171], v190, s[8:11], s12 offen offset:1280 sc1
    buffer_store_dwordx4 v[172:175], v190, s[8:11], s12 offen offset:1536 sc1
    buffer_store_dword v176, v191, s[8:11], s12 offen offset:1792 sc1
    buffer_store_dword v177, v191, s[8:11], s12 offen offset:1856 sc1
    v_lshrrev_b32 v146, 1, v0
    v_lshlrev_b32 v148, 11, v146
    s_lshl_b32 s59, s100, 3
    buffer_load_dwordx2 v[144:145], v148, s[80:83], s59 offen sc1
    s_waitcnt vmcnt(18)
    v_lshlrev_b32 v32, 16, v66
    v_and_b32 v33, s68, v66
    v_lshlrev_b32 v34, 16, v67
    v_and_b32 v35, s68, v67
    v_lshlrev_b32 v36, 16, v68
    v_and_b32 v37, s68, v68
    v_lshlrev_b32 v38, 16, v69
    v_and_b32 v39, s68, v69
    v_lshlrev_b32 v40, 16, v70
    v_and_b32 v41, s68, v70
    v_lshlrev_b32 v42, 16, v71
    v_and_b32 v43, s68, v71
    v_fma_f32 v32, v32, v99, v72
    v_fma_f32 v33, v33, v103, v72
    v_fma_f32 v34, v34, v107, v72
    v_fma_f32 v35, v35, v111, v72
    v_fma_f32 v36, v36, v99, v72
    v_fma_f32 v37, v37, v103, v72
    v_fma_f32 v38, v38, v107, v72
    v_fma_f32 v39, v39, v111, v72
    v_fma_f32 v40, v40, v99, v72
    v_fma_f32 v41, v41, v103, v72
    v_fma_f32 v42, v42, v107, v72
    v_fma_f32 v43, v43, v111, v72
    v_add_u32 v32, s70, v32
    v_add_u32 v33, s70, v33
    v_add_u32 v34, s70, v34
    v_add_u32 v35, s70, v35
    v_add_u32 v36, s70, v36
    v_add_u32 v37, s70, v37
    v_add_u32 v38, s70, v38
    v_add_u32 v39, s70, v39
    v_add_u32 v40, s70, v40
    v_add_u32 v41, s70, v41
    v_add_u32 v42, s70, v42
    v_add_u32 v43, s70, v43
    v_sub_u32_sdwa v33, v33, v32 dst_sel:DWORD dst_unused:UNUSED_PAD src0_sel:DWORD src1_sel:WORD_1
    v_sub_u32_sdwa v36, v36, v33 dst_sel:DWORD dst_unused:UNUSED_PAD src0_sel:DWORD src1_sel:WORD_1
    v_sub_u32_sdwa v37, v37, v36 dst_sel:DWORD dst_unused:UNUSED_PAD src0_sel:DWORD src1_sel:WORD_1
    v_perm_b32 v180, v33, v32, s45
    v_perm_b32 v181, v37, v36, s45
    v_sub_u32_sdwa v41, v41, v40 dst_sel:DWORD dst_unused:UNUSED_PAD src0_sel:DWORD src1_sel:WORD_1
    v_sub_u32_sdwa v115, v115, v41 dst_sel:DWORD dst_unused:UNUSED_PAD src0_sel:DWORD src1_sel:WORD_1
    v_sub_u32_sdwa v119, v119, v115 dst_sel:DWORD dst_unused:UNUSED_PAD src0_sel:DWORD src1_sel:WORD_1
    v_perm_b32 v182, v41, v40, s45
    v_perm_b32 v183, v119, v115, s45
    v_sub_u32_sdwa v35, v35, v34 dst_sel:DWORD dst_unused:UNUSED_PAD src0_sel:DWORD src1_sel:WORD_1
    v_sub_u32_sdwa v38, v38, v35 dst_sel:DWORD dst_unused:UNUSED_PAD src0_sel:DWORD src1_sel:WORD_1
    v_sub_u32_sdwa v39, v39, v38 dst_sel:DWORD dst_unused:UNUSED_PAD src0_sel:DWORD src1_sel:WORD_1
    v_perm_b32 v184, v35, v34, s45
    v_perm_b32 v185, v39, v38, s45
    v_sub_u32_sdwa v43, v43, v42 dst_sel:DWORD dst_unused:UNUSED_PAD src0_sel:DWORD src1_sel:WORD_1
    v_sub_u32_sdwa v123, v123, v43 dst_sel:DWORD dst_unused:UNUSED_PAD src0_sel:DWORD src1_sel:WORD_1
    v_sub_u32_sdwa v127, v127, v123 dst_sel:DWORD dst_unused:UNUSED_PAD src0_sel:DWORD src1_sel:WORD_1
    v_perm_b32 v186, v43, v42, s45
    v_perm_b32 v187, v127, v123, s45
    v_sub_u32_sdwa v87, v87, v83 dst_sel:DWORD dst_unused:UNUSED_PAD src0_sel:DWORD src1_sel:WORD_1
    v_sub_u32_sdwa v91, v91, v87 dst_sel:DWORD dst_unused:UNUSED_PAD src0_sel:DWORD src1_sel:WORD_1
    v_sub_u32_sdwa v95, v95, v91 dst_sel:DWORD dst_unused:UNUSED_PAD src0_sel:DWORD src1_sel:WORD_1
    v_perm_b32 v188, v87, v83, s45
    v_perm_b32 v189, v95, v91, s45
    s_mov_b32 s60, 0
    s_nop 0
    s_branch K_RLP_T
K_RLP:
    s_sleep 6
    s_mov_b64 exec, vcc
    buffer_load_dwordx2 v[144:145], v148, s[80:83], s59 offen sc1
    s_mov_b64 exec, -1
K_RLP_T:
    s_waitcnt vmcnt(0)
    v_xor_b32 v150, s27, v144
    v_xor_b32 v151, s26, v145
    v_lshrrev_b32 v150, 24, v150
    v_or_b32 v150, v150, v151
    v_cmp_ne_u32 vcc, 0, v150
    s_add_u32 s60, s60, 1
    s_cmp_lg_u64 vcc, 0
    s_cselect_b32 s3, s60, -1
    s_cmp_lt_u32 s3, 1048576
    s_nop 0
    s_cbranch_scc1 K_RLP
    v_mul_u32_u24 v146, 12544, v146
    v_and_b32 v148, 1, v0
    v_lshl_add_u32 v148, v148, 2, s50
    v_and_b32 v149, 0xfff, v144
    v_bfe_u32 v147, v144, 12, 12
    v_add_u32 v149, v149, v148
    v_sub_u32 v147, v147, v148
    v_lshl_add_u32 v146, v149, 2, v146
    v_cmp_lt_i32 vcc, s98, v147
    v_min_i32 v147, s98, v147
    s_cmp_lg_u64 vcc, 0
    s_cselect_b32 s51, 1, 0
    s_mov_b32 s49, 0
    v_cmp_lt_i32 vcc, 0, v147
    s_nop 0
    s_mov_b64 exec, vcc
    s_cbranch_execz K_RL
    buffer_load_dwordx4 v[128:131], v146, s[32:35], 0 offen offset:0 sc1
    s_mov_b32 s49, 1
    v_cmp_lt_i32 vcc, 8, v147
    s_nop 0
    s_mov_b64 exec, vcc
    s_cbranch_execz K_RL
    buffer_load_dwordx4 v[132:135], v146, s[32:35], 0 offen offset:32 sc1
    s_mov_b32 s49, 2
    v_cmp_lt_i32 vcc, 16, v147
    s_nop 0
    s_mov_b64 exec, vcc
    s_cbranch_execz K_RL
    buffer_load_dwordx4 v[136:139], v146, s[32:35], 0 offen offset:64 sc1
    s_mov_b32 s49, 3
    v_cmp_lt_i32 vcc, 24, v147
    s_nop 0
    s_mov_b64 exec, vcc
    s_cbranch_execz K_RL
    buffer_load_dwordx4 v[140:143], v146, s[32:35], 0 offen offset:96 sc1
    s_mov_b32 s49, 4
K_RL:
    s_mov_b64 exec, -1
K_S3:
    ds_read_b32 v239, v237 offset:4316
    s_waitcnt lgkmcnt(0)
    v_readfirstlane_b32 s3, v239
    s_nop 0
    s_cmp_lt_u32 s3, 8
    s_cbranch_scc1 K_S3
    s_lshl_b32 s3, s48, 10
    s_add_u32 s3, s3, 117248
    v_add_u32 v239, s3, v1
    ds_write_b128 v239, v[216:219] offset:0
    ds_write_b128 v239, v[220:223] offset:8192
    ds_write_b128 v239, v[224:227] offset:16384
    ds_write_b128 v239, v[228:231] offset:24576
    ds_write_b128 v239, v[232:235] offset:32768
    s_branch K_PH2
K_COMM:
    s_setprio 3
    s_mov_b32 s84, s22
    s_and_b32 s85, s23, 0xffff
    s_mov_b32 s86, 0x100
    s_mov_b32 s87, 0x20000
    s_or_b32 s26, s26, 1
    s_lshl_b32 s27, s27, 24
    s_cmp_eq_u32 s2, 0
    s_cbranch_scc0 K_T0
    v_mov_b32 v10, s26
    v_mov_b32 v11, s27
    s_mov_b64 exec, 1
    buffer_store_dwordx2 v[10:11], v237, s[84:87], 0 offen sc0 sc1
    s_mov_b64 exec, -1
K_T0:
    buffer_load_dwordx4 v[176:179], v239, s[32:35], s69 offen
    s_add_u32 s69, s69, s70
    buffer_load_dwordx4 v[180:183], v239, s[32:35], s69 offen
    s_add_u32 s69, s69, s70
    buffer_load_dwordx4 v[184:187], v239, s[32:35], s69 offen
    s_add_u32 s69, s69, s70
    buffer_load_dwordx4 v[188:191], v239, s[32:35], s69 offen
    s_barrier
    s_mov_b32 s36, s6
    s_and_b32 s37, s7, 0xffff
    s_mov_b32 s38, 0x249f0
    s_mov_b32 s39, 0x20000
    s_mov_b32 s28, s24
    s_and_b32 s29, s25, 0xffff
    s_mov_b32 s30, 0xf50000
    s_mov_b32 s31, 0x20000
    s_add_u32 s32, s24, 0x1000000
    s_addc_u32 s33, s25, 0
    s_and_b32 s33, s33, 0xffff
    s_mov_b32 s34, 0x310000
    s_mov_b32 s35, 0x20000
    s_add_u32 s80, s24, 0x1400000
    s_addc_u32 s81, s25, 0
    s_and_b32 s81, s81, 0xffff
    s_mov_b32 s82, 0x80000
    s_mov_b32 s83, 0x20000
    s_mov_b32 s44, 0x05040100
    s_mov_b32 s45, 0x07060302
    s_mov_b32 s88, s12
    s_and_b32 s89, s13, 0xffff
    s_mov_b32 s90, 0x20
    s_mov_b32 s91, 0x20000
    v_and_b32 v8, 7, v2
    v_lshlrev_b32 v8, 2, v8
    buffer_load_dword v9, v8, s[88:91], 0 offen
    s_mul_i32 s3, s100, 588
    v_mul_u32_u24 v8, 6, v2
    buffer_load_ushort v40, v8, s[36:39], s3 offen offset:0
    buffer_load_ushort v41, v8, s[36:39], s3 offen offset:2
    buffer_load_ushort v42, v8, s[36:39], s3 offen offset:4
    buffer_load_ushort v44, v8, s[36:39], s3 offen offset:384
    buffer_load_ushort v45, v8, s[36:39], s3 offen offset:386
    buffer_load_ushort v46, v8, s[36:39], s3 offen offset:388
    s_mov_b32 s88, s18
    s_and_b32 s89, s19, 0xffff
    s_mov_b32 s90, 0x1800
    s_mov_b32 s91, 0x20000
    s_cmp_eq_u32 s2, 0
    s_cbranch_scc0 K_C2
    v_mul_u32_u24 v8, 1536, v3
    v_lshl_add_u32 v8, v4, 2, v8
    buffer_load_dword v48, v8, s[88:91], 0 offen offset:0
    buffer_load_dword v49, v8, s[88:91], 0 offen offset:64
    buffer_load_dword v50, v8, s[88:91], 0 offen offset:384
    buffer_load_dword v51, v8, s[88:91], 0 offen offset:448
    buffer_load_dword v52, v8, s[88:91], 0 offen offset:768
    buffer_load_dword v53, v8, s[88:91], 0 offen offset:832
    buffer_load_dword v54, v8, s[88:91], 0 offen offset:1152
    buffer_load_dword v55, v8, s[88:91], 0 offen offset:1216
    buffer_load_dword v56, v8, s[88:91], 0 offen offset:128
    buffer_load_dword v57, v8, s[88:91], 0 offen offset:192
    buffer_load_dword v58, v8, s[88:91], 0 offen offset:512
    buffer_load_dword v59, v8, s[88:91], 0 offen offset:576
    buffer_load_dword v60, v8, s[88:91], 0 offen offset:896
    buffer_load_dword v61, v8, s[88:91], 0 offen offset:960
    buffer_load_dword v62, v8, s[88:91], 0 offen offset:1280
    buffer_load_dword v63, v8, s[88:91], 0 offen offset:1344
    buffer_load_dword v64, v8, s[88:91], 0 offen offset:256
    buffer_load_dword v65, v8, s[88:91], 0 offen offset:320
    buffer_load_dword v66, v8, s[88:91], 0 offen offset:640
    buffer_load_dword v67, v8, s[88:91], 0 offen offset:704
    buffer_load_dword v68, v8, s[88:91], 0 offen offset:1024
    buffer_load_dword v69, v8, s[88:91], 0 offen offset:1088
    buffer_load_dword v70, v8, s[88:91], 0 offen offset:1408
    buffer_load_dword v71, v8, s[88:91], 0 offen offset:1472
K_C2:
    s_mov_b32 s97, 0
    s_add_u32 m0, s97, 6656
    s_nop 0
    buffer_load_dwordx4 v1, s[36:39], s97 offen offset:0 lds
    buffer_load_dwordx4 v1, s[36:39], s97 offen offset:1024 lds
    buffer_load_dwordx4 v1, s[36:39], s97 offen offset:2048 lds
    buffer_load_dwordx4 v1, s[36:39], s97 offen offset:3072 lds
    s_add_u32 s97, s97, 4096
    s_add_u32 m0, s97, 6656
    s_nop 0
    buffer_load_dwordx4 v1, s[36:39], s97 offen offset:0 lds
    buffer_load_dwordx4 v1, s[36:39], s97 offen offset:1024 lds
    buffer_load_dwordx4 v1, s[36:39], s97 offen offset:2048 lds
    buffer_load_dwordx4 v1, s[36:39], s97 offen offset:3072 lds
    s_add_u32 s97, s97, 4096
    s_waitcnt vmcnt(15)
    v_perm_b32 v192, v180, v176, s44
    v_perm_b32 v193, v188, v184, s44
    v_perm_b32 v194, v180, v176, s45
    v_perm_b32 v195, v188, v184, s45
    v_perm_b32 v196, v181, v177, s44
    v_perm_b32 v197, v189, v185, s44
    v_perm_b32 v198, v181, v177, s45
    v_perm_b32 v199, v189, v185, s45
    v_perm_b32 v200, v182, v178, s44
    v_perm_b32 v201, v190, v186, s44
    v_perm_b32 v202, v182, v178, s45
    v_perm_b32 v203, v190, v186, s45
    v_perm_b32 v204, v183, v179, s44
    v_perm_b32 v205, v191, v187, s44
    v_perm_b32 v206, v183, v179, s45
    v_perm_b32 v207, v191, v187, s45
    s_lshl_b32 s3, s48, 12
    s_add_u32 s3, s3, 131072
    v_lshrrev_b32 v239, 2, v13
    v_lshl_add_u32 v239, v239, 11, s3
    v_lshl_add_u32 v239, v3, 8, v239
    v_and_b32 v240, 3, v13
    v_lshl_add_u32 v239, v240, 6, v239
    v_and_b32 v240, 1, v12
    v_lshl_add_u32 v239, v240, 3, v239
    ds_write_b64 v239, v[192:193] offset:0
    ds_write_b64 v239, v[194:195] offset:1024
    ds_write_b64 v239, v[196:197] offset:16
    ds_write_b64 v239, v[198:199] offset:1040
    ds_write_b64 v239, v[200:201] offset:32
    ds_write_b64 v239, v[202:203] offset:1056
    ds_write_b64 v239, v[204:205] offset:48
    ds_write_b64 v239, v[206:207] offset:1072
    s_mov_b64 exec, 1
    ds_add_u32 v237, v238 offset:4312
    s_mov_b64 exec, -1
    s_add_u32 m0, s97, 6656
    s_nop 0
    buffer_load_dwordx4 v1, s[36:39], s97 offen offset:0 lds
    buffer_load_dwordx4 v1, s[36:39], s97 offen offset:1024 lds
    buffer_load_dwordx4 v1, s[36:39], s97 offen offset:2048 lds
    buffer_load_dwordx4 v1, s[36:39], s97 offen offset:3072 lds
    s_add_u32 s97, s97, 4096
    s_add_u32 m0, s97, 6656
    s_nop 0
    buffer_load_dwordx4 v1, s[36:39], s97 offen offset:0 lds
    buffer_load_dwordx4 v1, s[36:39], s97 offen offset:1024 lds
    buffer_load_dwordx4 v1, s[36:39], s97 offen offset:2048 lds
    buffer_load_dwordx4 v1, s[36:39], s97 offen offset:3072 lds
    s_add_u32 s97, s97, 4096
    s_add_u32 m0, s97, 6656
    s_nop 0
    buffer_load_dwordx4 v1, s[36:39], s97 offen offset:0 lds
    buffer_load_dwordx4 v1, s[36:39], s97 offen offset:1024 lds
    buffer_load_dwordx4 v1, s[36:39], s97 offen offset:2048 lds
    buffer_load_dwordx4 v1, s[36:39], s97 offen offset:3072 lds
    s_add_u32 s97, s97, 4096
    s_add_u32 m0, s97, 6656
    s_nop 0
    buffer_load_dwordx4 v1, s[36:39], s97 offen offset:0 lds
    buffer_load_dwordx4 v1, s[36:39], s97 offen offset:1024 lds
    buffer_load_dwordx4 v1, s[36:39], s97 offen offset:2048 lds
    buffer_load_dwordx4 v1, s[36:39], s97 offen offset:3072 lds
    s_add_u32 s97, s97, 4096
    s_add_u32 m0, s97, 6656
    s_nop 0
    buffer_load_dwordx4 v1, s[36:39], s97 offen offset:0 lds
    buffer_load_dwordx4 v1, s[36:39], s97 offen offset:1024 lds
    buffer_load_dwordx4 v1, s[36:39], s97 offen offset:2048 lds
    buffer_load_dwordx4 v1, s[36:39], s97 offen offset:3072 lds
    s_add_u32 s97, s97, 4096
    s_add_u32 m0, s97, 6656
    s_nop 0
    buffer_load_dwordx4 v1, s[36:39], s97 offen offset:0 lds
    buffer_load_dwordx4 v1, s[36:39], s97 offen offset:1024 lds
    buffer_load_dwordx4 v1, s[36:39], s97 offen offset:2048 lds
    buffer_load_dwordx4 v1, s[36:39], s97 offen offset:3072 lds
    s_add_u32 s97, s97, 4096
    s_mov_b32 s3, 0
    s_branch K_T1T
K_T1:
    s_sleep 6
K_T1T:
    buffer_load_dwordx2 v[10:11], v237, s[84:87], 0 offen sc1
    s_add_u32 s3, s3, 1
    s_waitcnt vmcnt(0)
    v_readfirstlane_b32 s71, v10
    s_nop 0
    s_cmp_eq_u32 s71, 0
    s_cselect_b32 s71, s3, -1
    s_cmp_lt_u32 s71, 1048576
    s_nop 0
    s_cbranch_scc1 K_T1
    ds_write_b64 v237, v[10:11] offset:4288
    v_readfirstlane_b32 s26, v10
    v_readfirstlane_b32 s27, v11
    s_mov_b64 exec, 1
    ds_add_u32 v237, v238 offset:4320
    s_mov_b64 exec, -1
    v_add_u32 v12, 4096, v1
    v_add_u32 v13, 8192, v1
    v_add_u32 v14, 12288, v1
    s_add_u32 s88, s24, 0x1500000
    s_addc_u32 s89, s25, 0
    s_and_b32 s89, s89, 0xffff
    s_mov_b32 s90, 0x11400
    s_mov_b32 s91, 0x20000
    s_lshl_b32 s3, s2, 3
    s_add_u32 s3, s3, 0x38c0
    v_lshrrev_b32 v10, 3, v2
    v_add_lshl_u32 v10, v10, s3, 16
    v_rcp_f32 v11, v10
    v_lshlrev_b32 v16, 16, v9
    v_and_b32 v17, 0xffff0000, v9
    v_mul_f32 v16, v16, v10
    v_mul_f32 v17, v17, v10
    v_cvt_pk_bf16_f32 v16, 0, v16
    v_cvt_pk_bf16_f32 v17, 0, v17
    v_mul_f32 v16, 0.15915494, v16
    v_mul_f32 v17, 0.15915494, v17
    v_fract_f32 v16, v16
    v_fract_f32 v17, v17
    v_sin_f32 v16, v16
    v_sin_f32 v17, v17
    v_cvt_pk_bf16_f32 v16, 0, v16
    v_cvt_pk_bf16_f32 v17, 0, v17
    v_mul_f32 v16, v16, v11
    v_mul_f32 v17, v17, v11
    v_cvt_pk_bf16_f32 v16, v16, v17
    s_lshl_b32 s3, s2, 8
    v_lshlrev_b32 v8, 2, v2
    s_cmp_lt_u32 s2, 252
    s_cbranch_scc0 K_C3
    buffer_store_dword v16, v8, s[88:91], s3 offen sc1
K_C3:
    s_cmp_eq_u32 s2, 0
    s_cbranch_scc0 K_C4
    v_perm_b32 v176, v50, v48, s44
    v_perm_b32 v177, v54, v52, s44
    v_perm_b32 v178, v50, v48, s45
    v_perm_b32 v179, v54, v52, s45
    v_perm_b32 v180, v51, v49, s44
    v_perm_b32 v181, v55, v53, s44
    v_perm_b32 v182, v51, v49, s45
    v_perm_b32 v183, v55, v53, s45
    v_perm_b32 v184, v58, v56, s44
    v_perm_b32 v185, v62, v60, s44
    v_perm_b32 v186, v58, v56, s45
    v_perm_b32 v187, v62, v60, s45
    v_perm_b32 v188, v59, v57, s44
    v_perm_b32 v189, v63, v61, s44
    v_perm_b32 v190, v59, v57, s45
    v_perm_b32 v191, v63, v61, s45
    v_perm_b32 v192, v66, v64, s44
    v_perm_b32 v193, v70, v68, s44
    v_perm_b32 v194, v66, v64, s45
    v_perm_b32 v195, v70, v68, s45
    v_perm_b32 v196, v67, v65, s44
    v_perm_b32 v197, v71, v69, s44
    v_perm_b32 v198, v67, v65, s45
    v_perm_b32 v199, v71, v69, s45
    s_mov_b32 s3, 64512
    buffer_store_dwordx4 v[176:179], v1, s[88:91], s3 offen offset:0 sc1
    buffer_store_dwordx4 v[180:183], v1, s[88:91], s3 offen offset:1024 sc1
    buffer_store_dwordx4 v[184:187], v1, s[88:91], s3 offen offset:2048 sc1
    buffer_store_dwordx4 v[188:191], v1, s[88:91], s3 offen offset:3072 sc1
    buffer_store_dwordx4 v[192:195], v12, s[88:91], s3 offen offset:0 sc1
    buffer_store_dwordx4 v[196:199], v12, s[88:91], s3 offen offset:1024 sc1
K_C4:
    v_lshlrev_b32 v40, 16, v40
    v_lshlrev_b32 v41, 16, v41
    v_lshlrev_b32 v42, 16, v42
    v_lshlrev_b32 v44, 16, v44
    v_lshlrev_b32 v45, 16, v45
    v_lshlrev_b32 v46, 16, v46
    ds_write_b128 v1, v[40:43] offset:4864
    s_mov_b32 s72, -1
    s_mov_b32 s73, 0x3
    s_mov_b64 exec, s[72:73]
    ds_write_b128 v1, v[44:47] offset:5888
    s_mov_b64 exec, -1
K_C5:
    ds_read_b32 v239, v237 offset:4308
    s_waitcnt lgkmcnt(0)
    v_readfirstlane_b32 s3, v239
    s_nop 0
    s_cmp_ge_u32 s3, 7
    s_nop 2
    s_cbranch_scc1 K_C6
    s_cmp_lt_u32 s97, 86016
    s_cbranch_scc0 K_C5
    s_add_u32 m0, s97, 6656
    s_nop 0
    buffer_load_dwordx4 v1, s[36:39], s97 offen offset:0 lds
    buffer_load_dwordx4 v1, s[36:39], s97 offen offset:1024 lds
    buffer_load_dwordx4 v1, s[36:39], s97 offen offset:2048 lds
    buffer_load_dwordx4 v1, s[36:39], s97 offen offset:3072 lds
    s_add_u32 s97, s97, 4096
    s_branch K_C5
K_C6:
    v_add_u32 v8, 118528, v1
    ds_read_b128 v[72:75], v8 offset:0
    ds_read_b128 v[76:79], v8 offset:1024
    ds_read_b128 v[80:83], v8 offset:2048
    ds_read_b128 v[84:87], v8 offset:3072
    ds_read_b128 v[88:91], v8 offset:4096
    ds_read_b128 v[92:95], v8 offset:5120
    ds_read_b128 v[96:99], v8 offset:6144
    ds_read_b128 v[100:103], v8 offset:7168
    ds_read_b128 v[104:107], v8 offset:8192
    ds_read_b128 v[108:111], v8 offset:9216
    ds_read_b128 v[112:115], v8 offset:10240
    ds_read_b128 v[116:119], v8 offset:11264
    ds_read_b128 v[120:123], v8 offset:12288
    s_waitcnt lgkmcnt(12)
    buffer_store_dwordx4 v[72:75], v1, s[32:35], s64 offen offset:0 sc1
    s_waitcnt lgkmcnt(11)
    buffer_store_dwordx4 v[76:79], v1, s[32:35], s64 offen offset:1024 sc1
    s_waitcnt lgkmcnt(10)
    buffer_store_dwordx4 v[80:83], v1, s[32:35], s64 offen offset:2048 sc1
    s_waitcnt lgkmcnt(9)
    buffer_store_dwordx4 v[84:87], v1, s[32:35], s64 offen offset:3072 sc1
    s_waitcnt lgkmcnt(8)
    buffer_store_dwordx4 v[88:91], v12, s[32:35], s64 offen offset:0 sc1
    s_waitcnt lgkmcnt(7)
    buffer_store_dwordx4 v[92:95], v12, s[32:35], s64 offen offset:1024 sc1
    s_waitcnt lgkmcnt(6)
    buffer_store_dwordx4 v[96:99], v12, s[32:35], s64 offen offset:2048 sc1
    s_waitcnt lgkmcnt(5)
    buffer_store_dwordx4 v[100:103], v12, s[32:35], s64 offen offset:3072 sc1
    s_waitcnt lgkmcnt(4)
    buffer_store_dwordx4 v[104:107], v13, s[32:35], s64 offen offset:0 sc1
    s_waitcnt lgkmcnt(3)
    buffer_store_dwordx4 v[108:111], v13, s[32:35], s64 offen offset:1024 sc1
    s_waitcnt lgkmcnt(2)
    buffer_store_dwordx4 v[112:115], v13, s[32:35], s64 offen offset:2048 sc1
    s_waitcnt lgkmcnt(1)
    buffer_store_dwordx4 v[116:119], v13, s[32:35], s64 offen offset:3072 sc1
    s_waitcnt lgkmcnt(0)
    s_mov_b64 exec, 0xffff
    buffer_store_dwordx4 v[120:123], v14, s[32:35], s64 offen offset:0 sc1
    s_mov_b64 exec, -1
    s_mov_b64 exec, 1
    ds_add_u32 v237, v238 offset:4316
    s_mov_b64 exec, -1
    s_mov_b64 exec, 1
    ds_add_u32 v237, v238 offset:4324
    s_mov_b64 exec, -1
    ds_read_b128 v[200:203], v1 offset:2048
    s_waitcnt lgkmcnt(0)
    v_add_u32 v205, v200, v201
    v_add_u32 v206, v205, v202
    v_add_u32 v207, v206, v203
    v_mov_b32 v204, v207
    s_nop 1
    v_add_u32_dpp v204, v204, v204 row_shr:1 row_mask:0xf bank_mask:0xf
    s_nop 1
    v_add_u32_dpp v204, v204, v204 row_shr:2 row_mask:0xf bank_mask:0xf
    s_nop 1
    v_add_u32_dpp v204, v204, v204 row_shr:4 row_mask:0xf bank_mask:0xf
    s_nop 1
    v_add_u32_dpp v204, v204, v204 row_shr:8 row_mask:0xf bank_mask:0xf
    s_nop 1
    v_add_u32_dpp v204, v204, v204 row_bcast:15 row_mask:0xa bank_mask:0xf
    s_nop 1
    v_add_u32_dpp v204, v204, v204 row_bcast:31 row_mask:0xc bank_mask:0xf
    v_sub_u32 v208, v204, v207
    v_add_u32 v209, v208, v200
    v_add_u32 v210, v208, v205
    v_add_u32 v211, v208, v206
    v_lshl_or_b32 v24, v200, 12, v208
    v_or_b32 v24, s27, v24
    v_mov_b32 v25, s26
    v_lshl_or_b32 v26, v201, 12, v209
    v_or_b32 v26, s27, v26
    v_mov_b32 v27, s26
    v_lshl_or_b32 v28, v202, 12, v210
    v_or_b32 v28, s27, v28
    v_mov_b32 v29, s26
    v_lshl_or_b32 v30, v203, 12, v211
    v_or_b32 v30, s27, v30
    v_mov_b32 v31, s26
    v_lshlrev_b32 v8, 1, v1
    s_add_u32 m0, s97, 6656
    s_nop 0
    buffer_load_dwordx4 v1, s[36:39], s97 offen offset:0 lds
    buffer_load_dwordx4 v1, s[36:39], s97 offen offset:1024 lds
    buffer_load_dwordx4 v1, s[36:39], s97 offen offset:2048 lds
    buffer_load_dwordx4 v1, s[36:39], s97 offen offset:3072 lds
    s_add_u32 s97, s97, 4096
    s_add_u32 m0, s97, 6656
    s_nop 0
    buffer_load_dwordx4 v1, s[36:39], s97 offen offset:0 lds
    buffer_load_dwordx4 v1, s[36:39], s97 offen offset:1024 lds
    buffer_load_dwordx4 v1, s[36:39], s97 offen offset:2048 lds
    buffer_load_dwordx4 v1, s[36:39], s97 offen offset:3072 lds
    s_add_u32 s97, s97, 4096
    s_add_u32 m0, s97, 6656
    s_nop 0
    buffer_load_dwordx4 v1, s[36:39], s97 offen offset:0 lds
    buffer_load_dwordx4 v1, s[36:39], s97 offen offset:1024 lds
    buffer_load_dwordx4 v1, s[36:39], s97 offen offset:2048 lds
    buffer_load_dwordx4 v1, s[36:39], s97 offen offset:3072 lds
    s_add_u32 s97, s97, 4096
    s_add_u32 m0, s97, 6656
    s_nop 0
    buffer_load_dwordx4 v1, s[36:39], s97 offen offset:0 lds
    buffer_load_dwordx4 v1, s[36:39], s97 offen offset:1024 lds
    buffer_load_dwordx4 v1, s[36:39], s97 offen offset:2048 lds
    buffer_load_dwordx4 v1, s[36:39], s97 offen offset:3072 lds
    s_add_u32 s97, s97, 4096
    s_add_u32 m0, s97, 6656
    s_nop 0
    buffer_load_dwordx4 v1, s[36:39], s97 offen offset:0 lds
    buffer_load_dwordx4 v1, s[36:39], s97 offen offset:1024 lds
    buffer_load_dwordx4 v1, s[36:39], s97 offen offset:2048 lds
    buffer_load_dwordx4 v1, s[36:39], s97 offen offset:3072 lds
    s_add_u32 s97, s97, 4096
    s_add_u32 m0, s97, 6656
    s_nop 0
    buffer_load_dwordx4 v1, s[36:39], s97 offen offset:0 lds
    buffer_load_dwordx4 v1, s[36:39], s97 offen offset:1024 lds
    buffer_load_dwordx4 v1, s[36:39], s97 offen offset:2048 lds
    buffer_load_dwordx4 v1, s[36:39], s97 offen offset:3072 lds
    s_add_u32 s97, s97, 4096
    s_lshl_b32 s3, s2, 11
    s_waitcnt vmcnt(24)
    buffer_store_dwordx4 v[24:27], v8, s[80:83], s3 offen sc1
    buffer_store_dwordx4 v[28:31], v8, s[80:83], s3 offen offset:16 sc1
    s_nop 1
K_C7:
    s_cmp_lt_u32 s97, 110592
    s_cbranch_scc0 K_C8
    s_add_u32 m0, s97, 6656
    s_nop 0
    buffer_load_dwordx4 v1, s[36:39], s97 offen offset:0 lds
    buffer_load_dwordx4 v1, s[36:39], s97 offen offset:1024 lds
    buffer_load_dwordx4 v1, s[36:39], s97 offen offset:2048 lds
    buffer_load_dwordx4 v1, s[36:39], s97 offen offset:3072 lds
    s_add_u32 s97, s97, 4096
    s_branch K_C7
K_C8:
    s_lshl_b32 s3, s48, 10
    s_add_u32 s3, s3, 110592
    buffer_load_dwordx4 v[216:219], v1, s[36:39], s3 offen
    s_add_u32 s3, s3, 8192
    buffer_load_dwordx4 v[220:223], v1, s[36:39], s3 offen
    s_add_u32 s3, s3, 8192
    buffer_load_dwordx4 v[224:227], v1, s[36:39], s3 offen
    s_add_u32 s3, s3, 8192
    buffer_load_dwordx4 v[228:231], v1, s[36:39], s3 offen
    s_add_u32 s3, s3, 8192
    buffer_load_dwordx4 v[232:235], v1, s[36:39], s3 offen
    v_lshrrev_b32 v146, 1, v0
    v_lshlrev_b32 v148, 11, v146
    s_lshl_b32 s59, s100, 3
    buffer_load_dwordx2 v[144:145], v148, s[80:83], s59 offen sc1
    s_mov_b32 s60, 0
    s_branch K_RL7P_T
K_RL7P:
    s_sleep 6
    s_mov_b64 exec, vcc
    buffer_load_dwordx2 v[144:145], v148, s[80:83], s59 offen sc1
    s_mov_b64 exec, -1
K_RL7P_T:
    s_waitcnt vmcnt(0)
    v_xor_b32 v150, s27, v144
    v_xor_b32 v151, s26, v145
    v_lshrrev_b32 v150, 24, v150
    v_or_b32 v150, v150, v151
    v_cmp_ne_u32 vcc, 0, v150
    s_add_u32 s60, s60, 1
    s_cmp_lg_u64 vcc, 0
    s_cselect_b32 s3, s60, -1
    s_cmp_lt_u32 s3, 1048576
    s_nop 0
    s_cbranch_scc1 K_RL7P
    v_mul_u32_u24 v146, 12544, v146
    v_and_b32 v148, 1, v0
    v_lshl_add_u32 v148, v148, 2, s50
    v_and_b32 v149, 0xfff, v144
    v_bfe_u32 v147, v144, 12, 12
    v_add_u32 v149, v149, v148
    v_sub_u32 v147, v147, v148
    v_lshl_add_u32 v146, v149, 2, v146
    v_cmp_lt_i32 vcc, s98, v147
    v_min_i32 v147, s98, v147
    s_cmp_lg_u64 vcc, 0
    s_cselect_b32 s51, 1, 0
    s_mov_b32 s49, 0
    v_cmp_lt_i32 vcc, 0, v147
    s_nop 0
    s_mov_b64 exec, vcc
    s_cbranch_execz K_RL7
    buffer_load_dwordx4 v[128:131], v146, s[32:35], 0 offen offset:0 sc1
    s_mov_b32 s49, 1
    v_cmp_lt_i32 vcc, 8, v147
    s_nop 0
    s_mov_b64 exec, vcc
    s_cbranch_execz K_RL7
    buffer_load_dwordx4 v[132:135], v146, s[32:35], 0 offen offset:32 sc1
    s_mov_b32 s49, 2
    v_cmp_lt_i32 vcc, 16, v147
    s_nop 0
    s_mov_b64 exec, vcc
    s_cbranch_execz K_RL7
    buffer_load_dwordx4 v[136:139], v146, s[32:35], 0 offen offset:64 sc1
    s_mov_b32 s49, 3
    v_cmp_lt_i32 vcc, 24, v147
    s_nop 0
    s_mov_b64 exec, vcc
    s_cbranch_execz K_RL7
    buffer_load_dwordx4 v[140:143], v146, s[32:35], 0 offen offset:96 sc1
    s_mov_b32 s49, 4
K_RL7:
    s_mov_b64 exec, -1
K_S37:
    ds_read_b32 v239, v237 offset:4316
    s_waitcnt lgkmcnt(0)
    v_readfirstlane_b32 s3, v239
    s_nop 0
    s_cmp_lt_u32 s3, 8
    s_cbranch_scc1 K_S37
    s_lshl_b32 s3, s48, 10
    s_add_u32 s3, s3, 117248
    v_add_u32 v239, s3, v1
    ds_write_b128 v239, v[216:219] offset:0
    ds_write_b128 v239, v[220:223] offset:8192
    ds_write_b128 v239, v[224:227] offset:16384
    ds_write_b128 v239, v[228:231] offset:24576
    ds_write_b128 v239, v[232:235] offset:32768
    s_mov_b32 s8, s24
    s_and_b32 s9, s25, 0xffff
    s_mov_b32 s10, 0x0
    s_mov_b32 s11, 0x20000
    s_mov_b32 s12, 0
    v_mov_b32 v190, 0
    v_mov_b32 v191, 0
    s_waitcnt vmcnt(0)
    s_setprio 0
    s_branch K_PH2
K2_ROUND:
    v_and_b32 v15, 63, v0
    v_lshlrev_b32 v15, 4, v15
    s_lshl_b32 s97, s48, 10
    s_nop 0
K2_RD:
    s_add_u32 m0, s97, 6656
    s_nop 0
    buffer_load_dwordx4 v15, s[36:39], s97 offen lds
    s_add_u32 s97, s97, 8192
    s_cmp_lt_u32 s97, 150528
    s_cbranch_scc1 K2_RD
    v_lshlrev_b32 v20, 2, v0
    v_mov_b32 v21, 0
    ds_write_b32 v20, v21 offset:0
    s_add_u32 s40, s24, 0x1400000
    s_addc_u32 s41, s25, 0
    s_and_b32 s41, s41, 0xffff
    s_mov_b32 s42, 0x80000
    s_mov_b32 s43, 0x20000
    v_lshrrev_b32 v146, 1, v0
    v_lshlrev_b32 v148, 11, v146
    s_lshl_b32 s59, s100, 3
    buffer_load_dwordx2 v[144:145], v148, s[40:43], s59 offen sc1
    s_mov_b32 s60, 0
    s_branch K_RLRP_T
K_RLRP:
    s_sleep 6
    s_mov_b64 exec, vcc
    buffer_load_dwordx2 v[144:145], v148, s[40:43], s59 offen sc1
    s_mov_b64 exec, -1
K_RLRP_T:
    s_waitcnt vmcnt(0)
    v_xor_b32 v150, s27, v144
    v_xor_b32 v151, s26, v145
    v_lshrrev_b32 v150, 24, v150
    v_or_b32 v150, v150, v151
    v_cmp_ne_u32 vcc, 0, v150
    s_add_u32 s60, s60, 1
    s_cmp_lg_u64 vcc, 0
    s_cselect_b32 s3, s60, -1
    s_cmp_lt_u32 s3, 1048576
    s_nop 0
    s_cbranch_scc1 K_RLRP
    v_mul_u32_u24 v146, 12544, v146
    v_and_b32 v148, 1, v0
    v_lshl_add_u32 v148, v148, 2, s50
    v_and_b32 v149, 0xfff, v144
    v_bfe_u32 v147, v144, 12, 12
    v_add_u32 v149, v149, v148
    v_sub_u32 v147, v147, v148
    v_lshl_add_u32 v146, v149, 2, v146
    v_cmp_lt_i32 vcc, s98, v147
    v_min_i32 v147, s98, v147
    s_cmp_lg_u64 vcc, 0
    s_cselect_b32 s51, 1, 0
    s_mov_b32 s49, 0
    v_cmp_lt_i32 vcc, 0, v147
    s_nop 0
    s_mov_b64 exec, vcc
    s_cbranch_execz K_RLR
    buffer_load_dwordx4 v[128:131], v146, s[32:35], 0 offen offset:0 sc1
    s_mov_b32 s49, 1
    v_cmp_lt_i32 vcc, 8, v147
    s_nop 0
    s_mov_b64 exec, vcc
    s_cbranch_execz K_RLR
    buffer_load_dwordx4 v[132:135], v146, s[32:35], 0 offen offset:32 sc1
    s_mov_b32 s49, 2
    v_cmp_lt_i32 vcc, 16, v147
    s_nop 0
    s_mov_b64 exec, vcc
    s_cbranch_execz K_RLR
    buffer_load_dwordx4 v[136:139], v146, s[32:35], 0 offen offset:64 sc1
    s_mov_b32 s49, 3
    v_cmp_lt_i32 vcc, 24, v147
    s_nop 0
    s_mov_b64 exec, vcc
    s_cbranch_execz K_RLR
    buffer_load_dwordx4 v[140:143], v146, s[32:35], 0 offen offset:96 sc1
    s_mov_b32 s49, 4
K_RLR:
    s_mov_b64 exec, -1
    s_mov_b32 s8, s24
    s_and_b32 s9, s25, 0xffff
    s_mov_b32 s10, 0x0
    s_mov_b32 s11, 0x20000
    s_waitcnt vmcnt(0)
K_PH2:
    s_mov_b32 s57, 0xffff0000
    s_movk_i32 s58, 640
    s_mov_b32 s13, 6422528
    s_mov_b32 s22, 12845056
    s_movk_i32 s23, 128
    s_mov_b32 s61, 0x40490fdb
    s_mov_b32 s62, 0x3e4ccccd
    s_mov_b32 s63, 0x41c0cccd
    v_and_b32 v12, 63, v0
    v_and_b32 v14, 15, v0
    v_lshrrev_b32 v13, 4, v12
    v_lshlrev_b32 v15, 4, v12
    v_lshlrev_b32 v1, 4, v14
    v_lshlrev_b32 v2, 2, v14
    v_sub_u32 v3, 15, v14
    v_lshl_or_b32 v3, v3, 16, v3
    v_mov_b32 v11, 0xdddddddd
    v_lshlrev_b32 v4, 3, v13
    s_lshl_b32 s60, s48, 2
    v_mov_b32 v5, s60
    v_xor_b32 v6, 16, v5
    v_mov_b32 v34, 1
    v_mov_b32 v21, s51
    ds_write_b32 v5, v21 offset:4096
    s_cmp_eq_u32 s101, 0
    s_cbranch_scc1 K2_Z
    v_mov_b64 v[192:193], 0
    v_mov_b64 v[194:195], 0
    v_mov_b64 v[196:197], 0
    v_mov_b64 v[198:199], 0
    v_mov_b64 v[200:201], 0
    v_mov_b64 v[202:203], 0
    v_mov_b64 v[204:205], 0
    v_mov_b64 v[206:207], 0
    v_mov_b64 v[208:209], 0
    v_mov_b64 v[210:211], 0
    v_mov_b64 v[212:213], 0
    v_mov_b64 v[214:215], 0
    v_mov_b64 v[216:217], 0
    v_mov_b64 v[218:219], 0
    v_mov_b64 v[220:221], 0
    v_mov_b64 v[222:223], 0
    v_mov_b64 v[224:225], 0
    v_mov_b64 v[226:227], 0
    v_mov_b64 v[228:229], 0
    v_mov_b64 v[230:231], 0
    v_mov_b64 v[232:233], 0
    v_mov_b64 v[234:235], 0
    v_mov_b64 v[236:237], 0
    v_mov_b64 v[238:239], 0
    v_mov_b64 v[240:241], 0
    v_mov_b64 v[242:243], 0
    v_mov_b64 v[244:245], 0
    v_mov_b64 v[246:247], 0
    v_mov_b64 v[248:249], 0
    v_mov_b64 v[250:251], 0
    v_mov_b64 v[252:253], 0
    v_mov_b64 v[254:255], 0
K2_Z:
    s_add_u32 s44, s24, 0x1480000
    s_addc_u32 s45, s25, 0
    s_and_b32 s45, s45, 0xffff
    s_mov_b32 s46, 0x80000
    s_mov_b32 s47, 0x20000
    s_add_u32 s40, s24, 0x1500000
    s_addc_u32 s41, s25, 0
    s_and_b32 s41, s41, 0xffff
    s_mov_b32 s42, 0x11400
    s_mov_b32 s43, 0x20000
    s_movk_i32 s16, 6656
    s_waitcnt vmcnt(0) lgkmcnt(0)
    s_barrier
    buffer_store_dwordx4 v[180:183], v190, s[8:11], s12 offen offset:1920 sc1
    buffer_store_dwordx4 v[184:187], v190, s[8:11], s12 offen offset:2176 sc1
    s_cmp_gt_u32 s49, 0
    s_nop 0
    s_cbranch_scc0 K2_FL0
    v_cmp_lt_i32 s[64:65], 0, v147
    v_mad_u32_u16 v106, v128, 6, s16
    v_bfe_u32 v152, v128, 16, 7
    v_and_b32 v104, -4, v106
    v_lshlrev_b32 v152, 4, v152
    s_or_b64 exec, s[64:65], 1
    ds_read2_b32 v[104:105], v104 offset0:0 offset1:1
    ds_read_b128 v[152:155], v152 offset:4864
    s_mov_b64 exec, -1
    v_lshlrev_b32 v106, 3, v106
    v_lshrrev_b32 v107, 21, v128
    v_and_b32 v107, 0x7fc, v107
    v_cmp_lt_i32 s[66:67], 1, v147
    v_mad_u32_u16 v110, v129, 6, s16
    v_bfe_u32 v156, v129, 16, 7
    v_and_b32 v108, -4, v110
    v_lshlrev_b32 v156, 4, v156
    s_or_b64 exec, s[66:67], 1
    ds_read2_b32 v[108:109], v108 offset0:0 offset1:1
    ds_read_b128 v[156:159], v156 offset:4864
    s_mov_b64 exec, -1
    v_lshlrev_b32 v110, 3, v110
    v_lshrrev_b32 v111, 21, v129
    v_and_b32 v111, 0x7fc, v111
    v_cmp_lt_i32 s[68:69], 2, v147
    v_mad_u32_u16 v114, v130, 6, s16
    v_bfe_u32 v160, v130, 16, 7
    v_and_b32 v112, -4, v114
    v_lshlrev_b32 v160, 4, v160
    s_or_b64 exec, s[68:69], 1
    ds_read2_b32 v[112:113], v112 offset0:0 offset1:1
    ds_read_b128 v[160:163], v160 offset:4864
    s_mov_b64 exec, -1
    v_lshlrev_b32 v114, 3, v114
    v_lshrrev_b32 v115, 21, v130
    v_and_b32 v115, 0x7fc, v115
    v_cmp_lt_i32 s[70:71], 3, v147
    v_mad_u32_u16 v118, v131, 6, s16
    v_bfe_u32 v164, v131, 16, 7
    v_and_b32 v116, -4, v118
    v_lshlrev_b32 v164, 4, v164
    s_or_b64 exec, s[70:71], 1
    ds_read2_b32 v[116:117], v116 offset0:0 offset1:1
    ds_read_b128 v[164:167], v164 offset:4864
    s_mov_b64 exec, -1
    v_lshlrev_b32 v118, 3, v118
    v_lshrrev_b32 v119, 21, v131
    v_and_b32 v119, 0x7fc, v119
    s_waitcnt lgkmcnt(6)
    v_alignbit_b32 v104, v105, v104, v106
    v_lshrrev_b32 v105, v106, v105
    v_lshlrev_b32 v106, 16, v104
    v_and_b32 v104, s57, v104
    v_lshlrev_b32 v105, 16, v105
    v_sub_f32 v152, v106, v152
    v_sub_f32 v153, v104, v153
    v_sub_f32 v154, v105, v154
    v_mul_f32 v155, v152, v152
    v_cvt_pk_bf16_f32 v40, v152, v153
    v_fmac_f32 v155, v153, v153
    v_cvt_pk_bf16_f32 v41, 0, v154
    v_fmac_f32 v155, v154, v154
    v_cmp_gt_f32 vcc, s63, v155
    s_nop 0
    s_and_b64 s[64:65], s[64:65], vcc
    s_waitcnt lgkmcnt(4)
    v_alignbit_b32 v108, v109, v108, v110
    v_lshrrev_b32 v109, v110, v109
    v_lshlrev_b32 v110, 16, v108
    v_and_b32 v108, s57, v108
    v_lshlrev_b32 v109, 16, v109
    v_sub_f32 v156, v110, v156
    v_sub_f32 v157, v108, v157
    v_sub_f32 v158, v109, v158
    v_mul_f32 v159, v156, v156
    v_cvt_pk_bf16_f32 v42, v156, v157
    v_fmac_f32 v159, v157, v157
    v_cvt_pk_bf16_f32 v43, 0, v158
    v_fmac_f32 v159, v158, v158
    v_cmp_gt_f32 vcc, s63, v159
    s_nop 0
    s_and_b64 s[66:67], s[66:67], vcc
    s_waitcnt lgkmcnt(2)
    v_alignbit_b32 v112, v113, v112, v114
    v_lshrrev_b32 v113, v114, v113
    v_lshlrev_b32 v114, 16, v112
    v_and_b32 v112, s57, v112
    v_lshlrev_b32 v113, 16, v113
    v_sub_f32 v160, v114, v160
    v_sub_f32 v161, v112, v161
    v_sub_f32 v162, v113, v162
    v_mul_f32 v163, v160, v160
    v_cvt_pk_bf16_f32 v44, v160, v161
    v_fmac_f32 v163, v161, v161
    v_cvt_pk_bf16_f32 v45, 0, v162
    v_fmac_f32 v163, v162, v162
    v_cmp_gt_f32 vcc, s63, v163
    s_nop 0
    s_and_b64 s[68:69], s[68:69], vcc
    s_waitcnt lgkmcnt(0)
    v_alignbit_b32 v116, v117, v116, v118
    v_lshrrev_b32 v117, v118, v117
    v_lshlrev_b32 v118, 16, v116
    v_and_b32 v116, s57, v116
    v_lshlrev_b32 v117, 16, v117
    v_sub_f32 v164, v118, v164
    v_sub_f32 v165, v116, v165
    v_sub_f32 v166, v117, v166
    v_mul_f32 v167, v164, v164
    v_cvt_pk_bf16_f32 v46, v164, v165
    v_fmac_f32 v167, v165, v165
    v_cvt_pk_bf16_f32 v47, 0, v166
    v_fmac_f32 v167, v166, v166
    v_cmp_gt_f32 vcc, s63, v167
    s_nop 0
    s_and_b64 s[70:71], s[70:71], vcc
    s_mov_b64 exec, s[64:65]
    ds_add_rtn_u32 v72, v107, v34 offset:0
    s_mov_b64 exec, s[66:67]
    ds_add_rtn_u32 v73, v111, v34 offset:0
    s_mov_b64 exec, s[68:69]
    ds_add_rtn_u32 v74, v115, v34 offset:0
    s_mov_b64 exec, s[70:71]
    ds_add_rtn_u32 v75, v119, v34 offset:0
    s_mov_b64 exec, -1
K2_FL0:
    buffer_store_dword v188, v191, s[8:11], s12 offen offset:2432 sc1
    buffer_store_dword v189, v191, s[8:11], s12 offen offset:2496 sc1
    s_cmp_gt_u32 s49, 1
    s_cbranch_scc0 K2_FL1
    v_cmp_lt_i32 s[72:73], 8, v147
    v_mad_u32_u16 v106, v132, 6, s16
    v_bfe_u32 v152, v132, 16, 7
    v_and_b32 v104, -4, v106
    v_lshlrev_b32 v152, 4, v152
    s_or_b64 exec, s[72:73], 1
    ds_read2_b32 v[104:105], v104 offset0:0 offset1:1
    ds_read_b128 v[152:155], v152 offset:4864
    s_mov_b64 exec, -1
    v_lshlrev_b32 v106, 3, v106
    v_lshrrev_b32 v107, 21, v132
    v_and_b32 v107, 0x7fc, v107
    v_cmp_lt_i32 s[74:75], 9, v147
    v_mad_u32_u16 v110, v133, 6, s16
    v_bfe_u32 v156, v133, 16, 7
    v_and_b32 v108, -4, v110
    v_lshlrev_b32 v156, 4, v156
    s_or_b64 exec, s[74:75], 1
    ds_read2_b32 v[108:109], v108 offset0:0 offset1:1
    ds_read_b128 v[156:159], v156 offset:4864
    s_mov_b64 exec, -1
    v_lshlrev_b32 v110, 3, v110
    v_lshrrev_b32 v111, 21, v133
    v_and_b32 v111, 0x7fc, v111
    v_cmp_lt_i32 s[76:77], 10, v147
    v_mad_u32_u16 v114, v134, 6, s16
    v_bfe_u32 v160, v134, 16, 7
    v_and_b32 v112, -4, v114
    v_lshlrev_b32 v160, 4, v160
    s_or_b64 exec, s[76:77], 1
    ds_read2_b32 v[112:113], v112 offset0:0 offset1:1
    ds_read_b128 v[160:163], v160 offset:4864
    s_mov_b64 exec, -1
    v_lshlrev_b32 v114, 3, v114
    v_lshrrev_b32 v115, 21, v134
    v_and_b32 v115, 0x7fc, v115
    v_cmp_lt_i32 s[78:79], 11, v147
    v_mad_u32_u16 v118, v135, 6, s16
    v_bfe_u32 v164, v135, 16, 7
    v_and_b32 v116, -4, v118
    v_lshlrev_b32 v164, 4, v164
    s_or_b64 exec, s[78:79], 1
    ds_read2_b32 v[116:117], v116 offset0:0 offset1:1
    ds_read_b128 v[164:167], v164 offset:4864
    s_mov_b64 exec, -1
    v_lshlrev_b32 v118, 3, v118
    v_lshrrev_b32 v119, 21, v135
    v_and_b32 v119, 0x7fc, v119
    s_waitcnt lgkmcnt(6)
    v_alignbit_b32 v104, v105, v104, v106
    v_lshrrev_b32 v105, v106, v105
    v_lshlrev_b32 v106, 16, v104
    v_and_b32 v104, s57, v104
    v_lshlrev_b32 v105, 16, v105
    v_sub_f32 v152, v106, v152
    v_sub_f32 v153, v104, v153
    v_sub_f32 v154, v105, v154
    v_mul_f32 v155, v152, v152
    v_cvt_pk_bf16_f32 v48, v152, v153
    v_fmac_f32 v155, v153, v153
    v_cvt_pk_bf16_f32 v49, 0, v154
    v_fmac_f32 v155, v154, v154
    v_cmp_gt_f32 vcc, s63, v155
    s_nop 0
    s_and_b64 s[72:73], s[72:73], vcc
    s_waitcnt lgkmcnt(4)
    v_alignbit_b32 v108, v109, v108, v110
    v_lshrrev_b32 v109, v110, v109
    v_lshlrev_b32 v110, 16, v108
    v_and_b32 v108, s57, v108
    v_lshlrev_b32 v109, 16, v109
    v_sub_f32 v156, v110, v156
    v_sub_f32 v157, v108, v157
    v_sub_f32 v158, v109, v158
    v_mul_f32 v159, v156, v156
    v_cvt_pk_bf16_f32 v50, v156, v157
    v_fmac_f32 v159, v157, v157
    v_cvt_pk_bf16_f32 v51, 0, v158
    v_fmac_f32 v159, v158, v158
    v_cmp_gt_f32 vcc, s63, v159
    s_nop 0
    s_and_b64 s[74:75], s[74:75], vcc
    s_waitcnt lgkmcnt(2)
    v_alignbit_b32 v112, v113, v112, v114
    v_lshrrev_b32 v113, v114, v113
    v_lshlrev_b32 v114, 16, v112
    v_and_b32 v112, s57, v112
    v_lshlrev_b32 v113, 16, v113
    v_sub_f32 v160, v114, v160
    v_sub_f32 v161, v112, v161
    v_sub_f32 v162, v113, v162
    v_mul_f32 v163, v160, v160
    v_cvt_pk_bf16_f32 v52, v160, v161
    v_fmac_f32 v163, v161, v161
    v_cvt_pk_bf16_f32 v53, 0, v162
    v_fmac_f32 v163, v162, v162
    v_cmp_gt_f32 vcc, s63, v163
    s_nop 0
    s_and_b64 s[76:77], s[76:77], vcc
    s_waitcnt lgkmcnt(0)
    v_alignbit_b32 v116, v117, v116, v118
    v_lshrrev_b32 v117, v118, v117
    v_lshlrev_b32 v118, 16, v116
    v_and_b32 v116, s57, v116
    v_lshlrev_b32 v117, 16, v117
    v_sub_f32 v164, v118, v164
    v_sub_f32 v165, v116, v165
    v_sub_f32 v166, v117, v166
    v_mul_f32 v167, v164, v164
    v_cvt_pk_bf16_f32 v54, v164, v165
    v_fmac_f32 v167, v165, v165
    v_cvt_pk_bf16_f32 v55, 0, v166
    v_fmac_f32 v167, v166, v166
    v_cmp_gt_f32 vcc, s63, v167
    s_nop 0
    s_and_b64 s[78:79], s[78:79], vcc
    s_mov_b64 exec, s[72:73]
    ds_add_rtn_u32 v76, v107, v34 offset:0
    s_mov_b64 exec, s[74:75]
    ds_add_rtn_u32 v77, v111, v34 offset:0
    s_mov_b64 exec, s[76:77]
    ds_add_rtn_u32 v78, v115, v34 offset:0
    s_mov_b64 exec, s[78:79]
    ds_add_rtn_u32 v79, v119, v34 offset:0
    s_mov_b64 exec, -1
K2_FL1:
    s_cmp_gt_u32 s49, 2
    s_cbranch_scc0 K2_FL2
    v_cmp_lt_i32 s[80:81], 16, v147
    v_mad_u32_u16 v106, v136, 6, s16
    v_bfe_u32 v152, v136, 16, 7
    v_and_b32 v104, -4, v106
    v_lshlrev_b32 v152, 4, v152
    s_or_b64 exec, s[80:81], 1
    ds_read2_b32 v[104:105], v104 offset0:0 offset1:1
    ds_read_b128 v[152:155], v152 offset:4864
    s_mov_b64 exec, -1
    v_lshlrev_b32 v106, 3, v106
    v_lshrrev_b32 v107, 21, v136
    v_and_b32 v107, 0x7fc, v107
    v_cmp_lt_i32 s[82:83], 17, v147
    v_mad_u32_u16 v110, v137, 6, s16
    v_bfe_u32 v156, v137, 16, 7
    v_and_b32 v108, -4, v110
    v_lshlrev_b32 v156, 4, v156
    s_or_b64 exec, s[82:83], 1
    ds_read2_b32 v[108:109], v108 offset0:0 offset1:1
    ds_read_b128 v[156:159], v156 offset:4864
    s_mov_b64 exec, -1
    v_lshlrev_b32 v110, 3, v110
    v_lshrrev_b32 v111, 21, v137
    v_and_b32 v111, 0x7fc, v111
    v_cmp_lt_i32 s[84:85], 18, v147
    v_mad_u32_u16 v114, v138, 6, s16
    v_bfe_u32 v160, v138, 16, 7
    v_and_b32 v112, -4, v114
    v_lshlrev_b32 v160, 4, v160
    s_or_b64 exec, s[84:85], 1
    ds_read2_b32 v[112:113], v112 offset0:0 offset1:1
    ds_read_b128 v[160:163], v160 offset:4864
    s_mov_b64 exec, -1
    v_lshlrev_b32 v114, 3, v114
    v_lshrrev_b32 v115, 21, v138
    v_and_b32 v115, 0x7fc, v115
    v_cmp_lt_i32 s[86:87], 19, v147
    v_mad_u32_u16 v118, v139, 6, s16
    v_bfe_u32 v164, v139, 16, 7
    v_and_b32 v116, -4, v118
    v_lshlrev_b32 v164, 4, v164
    s_or_b64 exec, s[86:87], 1
    ds_read2_b32 v[116:117], v116 offset0:0 offset1:1
    ds_read_b128 v[164:167], v164 offset:4864
    s_mov_b64 exec, -1
    v_lshlrev_b32 v118, 3, v118
    v_lshrrev_b32 v119, 21, v139
    v_and_b32 v119, 0x7fc, v119
    s_waitcnt lgkmcnt(6)
    v_alignbit_b32 v104, v105, v104, v106
    v_lshrrev_b32 v105, v106, v105
    v_lshlrev_b32 v106, 16, v104
    v_and_b32 v104, s57, v104
    v_lshlrev_b32 v105, 16, v105
    v_sub_f32 v152, v106, v152
    v_sub_f32 v153, v104, v153
    v_sub_f32 v154, v105, v154
    v_mul_f32 v155, v152, v152
    v_cvt_pk_bf16_f32 v56, v152, v153
    v_fmac_f32 v155, v153, v153
    v_cvt_pk_bf16_f32 v57, 0, v154
    v_fmac_f32 v155, v154, v154
    v_cmp_gt_f32 vcc, s63, v155
    s_nop 0
    s_and_b64 s[80:81], s[80:81], vcc
    s_waitcnt lgkmcnt(4)
    v_alignbit_b32 v108, v109, v108, v110
    v_lshrrev_b32 v109, v110, v109
    v_lshlrev_b32 v110, 16, v108
    v_and_b32 v108, s57, v108
    v_lshlrev_b32 v109, 16, v109
    v_sub_f32 v156, v110, v156
    v_sub_f32 v157, v108, v157
    v_sub_f32 v158, v109, v158
    v_mul_f32 v159, v156, v156
    v_cvt_pk_bf16_f32 v58, v156, v157
    v_fmac_f32 v159, v157, v157
    v_cvt_pk_bf16_f32 v59, 0, v158
    v_fmac_f32 v159, v158, v158
    v_cmp_gt_f32 vcc, s63, v159
    s_nop 0
    s_and_b64 s[82:83], s[82:83], vcc
    s_waitcnt lgkmcnt(2)
    v_alignbit_b32 v112, v113, v112, v114
    v_lshrrev_b32 v113, v114, v113
    v_lshlrev_b32 v114, 16, v112
    v_and_b32 v112, s57, v112
    v_lshlrev_b32 v113, 16, v113
    v_sub_f32 v160, v114, v160
    v_sub_f32 v161, v112, v161
    v_sub_f32 v162, v113, v162
    v_mul_f32 v163, v160, v160
    v_cvt_pk_bf16_f32 v60, v160, v161
    v_fmac_f32 v163, v161, v161
    v_cvt_pk_bf16_f32 v61, 0, v162
    v_fmac_f32 v163, v162, v162
    v_cmp_gt_f32 vcc, s63, v163
    s_nop 0
    s_and_b64 s[84:85], s[84:85], vcc
    s_waitcnt lgkmcnt(0)
    v_alignbit_b32 v116, v117, v116, v118
    v_lshrrev_b32 v117, v118, v117
    v_lshlrev_b32 v118, 16, v116
    v_and_b32 v116, s57, v116
    v_lshlrev_b32 v117, 16, v117
    v_sub_f32 v164, v118, v164
    v_sub_f32 v165, v116, v165
    v_sub_f32 v166, v117, v166
    v_mul_f32 v167, v164, v164
    v_cvt_pk_bf16_f32 v62, v164, v165
    v_fmac_f32 v167, v165, v165
    v_cvt_pk_bf16_f32 v63, 0, v166
    v_fmac_f32 v167, v166, v166
    v_cmp_gt_f32 vcc, s63, v167
    s_nop 0
    s_and_b64 s[86:87], s[86:87], vcc
    s_mov_b64 exec, s[80:81]
    ds_add_rtn_u32 v80, v107, v34 offset:0
    s_mov_b64 exec, s[82:83]
    ds_add_rtn_u32 v81, v111, v34 offset:0
    s_mov_b64 exec, s[84:85]
    ds_add_rtn_u32 v82, v115, v34 offset:0
    s_mov_b64 exec, s[86:87]
    ds_add_rtn_u32 v83, v119, v34 offset:0
    s_mov_b64 exec, -1
K2_FL2:
    s_cmp_gt_u32 s49, 3
    s_cbranch_scc0 K2_FL3
    v_cmp_lt_i32 s[88:89], 24, v147
    v_mad_u32_u16 v106, v140, 6, s16
    v_bfe_u32 v152, v140, 16, 7
    v_and_b32 v104, -4, v106
    v_lshlrev_b32 v152, 4, v152
    s_or_b64 exec, s[88:89], 1
    ds_read2_b32 v[104:105], v104 offset0:0 offset1:1
    ds_read_b128 v[152:155], v152 offset:4864
    s_mov_b64 exec, -1
    v_lshlrev_b32 v106, 3, v106
    v_lshrrev_b32 v107, 21, v140
    v_and_b32 v107, 0x7fc, v107
    v_cmp_lt_i32 s[90:91], 25, v147
    v_mad_u32_u16 v110, v141, 6, s16
    v_bfe_u32 v156, v141, 16, 7
    v_and_b32 v108, -4, v110
    v_lshlrev_b32 v156, 4, v156
    s_or_b64 exec, s[90:91], 1
    ds_read2_b32 v[108:109], v108 offset0:0 offset1:1
    ds_read_b128 v[156:159], v156 offset:4864
    s_mov_b64 exec, -1
    v_lshlrev_b32 v110, 3, v110
    v_lshrrev_b32 v111, 21, v141
    v_and_b32 v111, 0x7fc, v111
    v_cmp_lt_i32 s[92:93], 26, v147
    v_mad_u32_u16 v114, v142, 6, s16
    v_bfe_u32 v160, v142, 16, 7
    v_and_b32 v112, -4, v114
    v_lshlrev_b32 v160, 4, v160
    s_or_b64 exec, s[92:93], 1
    ds_read2_b32 v[112:113], v112 offset0:0 offset1:1
    ds_read_b128 v[160:163], v160 offset:4864
    s_mov_b64 exec, -1
    v_lshlrev_b32 v114, 3, v114
    v_lshrrev_b32 v115, 21, v142
    v_and_b32 v115, 0x7fc, v115
    v_cmp_lt_i32 s[94:95], 27, v147
    v_mad_u32_u16 v118, v143, 6, s16
    v_bfe_u32 v164, v143, 16, 7
    v_and_b32 v116, -4, v118
    v_lshlrev_b32 v164, 4, v164
    s_or_b64 exec, s[94:95], 1
    ds_read2_b32 v[116:117], v116 offset0:0 offset1:1
    ds_read_b128 v[164:167], v164 offset:4864
    s_mov_b64 exec, -1
    v_lshlrev_b32 v118, 3, v118
    v_lshrrev_b32 v119, 21, v143
    v_and_b32 v119, 0x7fc, v119
    s_waitcnt lgkmcnt(6)
    v_alignbit_b32 v104, v105, v104, v106
    v_lshrrev_b32 v105, v106, v105
    v_lshlrev_b32 v106, 16, v104
    v_and_b32 v104, s57, v104
    v_lshlrev_b32 v105, 16, v105
    v_sub_f32 v152, v106, v152
    v_sub_f32 v153, v104, v153
    v_sub_f32 v154, v105, v154
    v_mul_f32 v155, v152, v152
    v_cvt_pk_bf16_f32 v64, v152, v153
    v_fmac_f32 v155, v153, v153
    v_cvt_pk_bf16_f32 v65, 0, v154
    v_fmac_f32 v155, v154, v154
    v_cmp_gt_f32 vcc, s63, v155
    s_nop 0
    s_and_b64 s[88:89], s[88:89], vcc
    s_waitcnt lgkmcnt(4)
    v_alignbit_b32 v108, v109, v108, v110
    v_lshrrev_b32 v109, v110, v109
    v_lshlrev_b32 v110, 16, v108
    v_and_b32 v108, s57, v108
    v_lshlrev_b32 v109, 16, v109
    v_sub_f32 v156, v110, v156
    v_sub_f32 v157, v108, v157
    v_sub_f32 v158, v109, v158
    v_mul_f32 v159, v156, v156
    v_cvt_pk_bf16_f32 v66, v156, v157
    v_fmac_f32 v159, v157, v157
    v_cvt_pk_bf16_f32 v67, 0, v158
    v_fmac_f32 v159, v158, v158
    v_cmp_gt_f32 vcc, s63, v159
    s_nop 0
    s_and_b64 s[90:91], s[90:91], vcc
    s_waitcnt lgkmcnt(2)
    v_alignbit_b32 v112, v113, v112, v114
    v_lshrrev_b32 v113, v114, v113
    v_lshlrev_b32 v114, 16, v112
    v_and_b32 v112, s57, v112
    v_lshlrev_b32 v113, 16, v113
    v_sub_f32 v160, v114, v160
    v_sub_f32 v161, v112, v161
    v_sub_f32 v162, v113, v162
    v_mul_f32 v163, v160, v160
    v_cvt_pk_bf16_f32 v68, v160, v161
    v_fmac_f32 v163, v161, v161
    v_cvt_pk_bf16_f32 v69, 0, v162
    v_fmac_f32 v163, v162, v162
    v_cmp_gt_f32 vcc, s63, v163
    s_nop 0
    s_and_b64 s[92:93], s[92:93], vcc
    s_waitcnt lgkmcnt(0)
    v_alignbit_b32 v116, v117, v116, v118
    v_lshrrev_b32 v117, v118, v117
    v_lshlrev_b32 v118, 16, v116
    v_and_b32 v116, s57, v116
    v_lshlrev_b32 v117, 16, v117
    v_sub_f32 v164, v118, v164
    v_sub_f32 v165, v116, v165
    v_sub_f32 v166, v117, v166
    v_mul_f32 v167, v164, v164
    v_cvt_pk_bf16_f32 v70, v164, v165
    v_fmac_f32 v167, v165, v165
    v_cvt_pk_bf16_f32 v71, 0, v166
    v_fmac_f32 v167, v166, v166
    v_cmp_gt_f32 vcc, s63, v167
    s_nop 0
    s_and_b64 s[94:95], s[94:95], vcc
    s_mov_b64 exec, s[88:89]
    ds_add_rtn_u32 v84, v107, v34 offset:0
    s_mov_b64 exec, s[90:91]
    ds_add_rtn_u32 v85, v111, v34 offset:0
    s_mov_b64 exec, s[92:93]
    ds_add_rtn_u32 v86, v115, v34 offset:0
    s_mov_b64 exec, s[94:95]
    ds_add_rtn_u32 v87, v119, v34 offset:0
    s_mov_b64 exec, -1
K2_FL3:
    v_lshlrev_b32 v19, 5, v12
    v_mov_b32 v20, 0
    v_and_b32 v21, 7, v12
    v_cmp_eq_u32 s[14:15], 7, v21
    v_lshlrev_b32 v21, 2, v21
    v_lshrrev_b32 v31, 3, v12
    v_sub_u32 v32, 7, v31
    v_lshlrev_b32 v31, 2, v31
    v_lshrrev_b32 v33, 1, v0
    v_lshlrev_b32 v33, 11, v33
    s_lshl_b32 s97, s48, 10
    s_waitcnt vmcnt(0) lgkmcnt(0)
    s_barrier
    s_lshl_b32 s3, s101, 3
    s_add_u32 s3, s3, s48
    s_cmp_eq_u32 s3, 15
    s_cbranch_scc0 K2_TF
    v_mov_b32 v24, s27
    v_mov_b32 v25, s26
    v_mov_b32 v26, s27
    v_mov_b32 v27, s26
    s_lshl_b32 s3, s2, 11
    buffer_store_dwordx4 v[24:27], v15, s[44:47], s3 offen sc1
    buffer_store_dwordx4 v[24:27], v15, s[44:47], s3 offen offset:1024 sc1
K2_TF:
    ds_read_b128 v[104:107], v19 offset:0
    ds_read_b128 v[108:111], v19 offset:16
    ds_read_b128 v[180:183], v20 offset:4096
    ds_read_b128 v[184:187], v20 offset:4112
    s_add_u32 m0, s97, 93184
    s_nop 0
    buffer_load_dwordx4 v15, s[40:43], s97 offen lds
    s_add_u32 s97, s97, 8192
    s_add_u32 m0, s97, 93184
    s_nop 0
    buffer_load_dwordx4 v15, s[40:43], s97 offen lds
    s_add_u32 s97, s97, 8192
    s_mov_b32 s101, 0
    s_waitcnt lgkmcnt(2)
    v_add_u32 v105, v105, v104
    v_add_u32 v106, v106, v105
    v_add_u32 v107, v107, v106
    v_add_u32 v108, v108, v107
    v_add_u32 v109, v109, v108
    v_add_u32 v110, v110, v109
    v_add_u32 v111, v111, v110
    v_mov_b32 v28, v111
    s_nop 1
    v_add_u32_dpp v28, v28, v28 row_shr:1 row_mask:0xf bank_mask:0xf
    s_nop 1
    v_add_u32_dpp v28, v28, v28 row_shr:2 row_mask:0xf bank_mask:0xf
    s_nop 1
    v_add_u32_dpp v28, v28, v28 row_shr:4 row_mask:0xf bank_mask:0xf
    v_sub_u32 v29, 0, v28
    v_lshl_or_b32 v32, v28, 3, v32
    v_and_b32 v29, 63, v29
    s_mov_b64 exec, s[14:15]
    ds_write_b32 v31, v32 offset:4224
    s_mov_b64 exec, -1
    v_cndmask_b32 v29, 0, v29, s[14:15]
    v_add_u32 v29, v29, v111
    s_add_u32 m0, s97, 93184
    s_nop 0
    buffer_load_dwordx4 v15, s[40:43], s97 offen lds
    s_add_u32 s97, s97, 8192
    s_add_u32 m0, s97, 93184
    s_nop 0
    buffer_load_dwordx4 v15, s[40:43], s97 offen lds
    s_add_u32 s97, s97, 8192
    v_mov_b32 v35, v29
    s_nop 1
    v_add_u32_dpp v35, v35, v35 row_shr:1 row_mask:0xf bank_mask:0xf
    s_nop 1
    v_add_u32_dpp v35, v35, v35 row_shr:2 row_mask:0xf bank_mask:0xf
    s_nop 1
    v_add_u32_dpp v35, v35, v35 row_shr:4 row_mask:0xf bank_mask:0xf
    s_nop 1
    v_add_u32_dpp v35, v35, v35 row_shr:8 row_mask:0xf bank_mask:0xf
    s_nop 1
    v_add_u32_dpp v35, v35, v35 row_bcast:15 row_mask:0xa bank_mask:0xf
    s_nop 1
    v_add_u32_dpp v35, v35, v35 row_bcast:31 row_mask:0xc bank_mask:0xf
    v_sub_u32 v112, v35, v29
    v_add_u32 v113, v112, v104
    v_add_u32 v114, v112, v105
    v_add_u32 v115, v112, v106
    v_add_u32 v116, v112, v107
    v_add_u32 v117, v112, v108
    v_add_u32 v118, v112, v109
    v_add_u32 v119, v112, v110
    ds_write_b128 v19, v[112:115] offset:2048
    ds_write_b128 v19, v[116:119] offset:2064
    ds_read_b32 v24, v21 offset:4224
    ds_read_b32 v25, v31 offset:4224
    s_add_u32 m0, s97, 93184
    s_nop 0
    buffer_load_dwordx4 v15, s[40:43], s97 offen lds
    s_add_u32 s97, s97, 8192
    s_add_u32 m0, s97, 93184
    s_nop 0
    buffer_load_dwordx4 v15, s[40:43], s97 offen lds
    s_add_u32 s97, s97, 8192
    v_readlane_b32 s59, v35, 63
    s_nop 0
    s_cmp_gt_u32 s59, 5408
    s_nop 2
    s_cbranch_scc1 K2_RETRY
    s_cmp_gt_u32 s49, 0
    s_cbranch_scc0 K2_SC1
    s_mov_b64 exec, s[64:65]
    v_lshrrev_b32 v152, 21, v128
    v_and_b32 v152, 0x7fc, v152
    ds_read_b32 v152, v152 offset:2048
    s_mov_b64 exec, s[66:67]
    v_lshrrev_b32 v153, 21, v129
    v_and_b32 v153, 0x7fc, v153
    ds_read_b32 v153, v153 offset:2048
    s_mov_b64 exec, s[68:69]
    v_lshrrev_b32 v154, 21, v130
    v_and_b32 v154, 0x7fc, v154
    ds_read_b32 v154, v154 offset:2048
    s_mov_b64 exec, s[70:71]
    v_lshrrev_b32 v155, 21, v131
    v_and_b32 v155, 0x7fc, v155
    ds_read_b32 v155, v155 offset:2048
    s_cmp_gt_u32 s49, 1
    s_cbranch_scc0 K2_SC1
    s_mov_b64 exec, s[72:73]
    v_lshrrev_b32 v156, 21, v132
    v_and_b32 v156, 0x7fc, v156
    ds_read_b32 v156, v156 offset:2048
    s_mov_b64 exec, s[74:75]
    v_lshrrev_b32 v157, 21, v133
    v_and_b32 v157, 0x7fc, v157
    ds_read_b32 v157, v157 offset:2048
    s_mov_b64 exec, s[76:77]
    v_lshrrev_b32 v158, 21, v134
    v_and_b32 v158, 0x7fc, v158
    ds_read_b32 v158, v158 offset:2048
    s_mov_b64 exec, s[78:79]
    v_lshrrev_b32 v159, 21, v135
    v_and_b32 v159, 0x7fc, v159
    ds_read_b32 v159, v159 offset:2048
    s_cmp_gt_u32 s49, 2
    s_cbranch_scc0 K2_SC1
    s_mov_b64 exec, s[80:81]
    v_lshrrev_b32 v160, 21, v136
    v_and_b32 v160, 0x7fc, v160
    ds_read_b32 v160, v160 offset:2048
    s_mov_b64 exec, s[82:83]
    v_lshrrev_b32 v161, 21, v137
    v_and_b32 v161, 0x7fc, v161
    ds_read_b32 v161, v161 offset:2048
    s_mov_b64 exec, s[84:85]
    v_lshrrev_b32 v162, 21, v138
    v_and_b32 v162, 0x7fc, v162
    ds_read_b32 v162, v162 offset:2048
    s_mov_b64 exec, s[86:87]
    v_lshrrev_b32 v163, 21, v139
    v_and_b32 v163, 0x7fc, v163
    ds_read_b32 v163, v163 offset:2048
    s_cmp_gt_u32 s49, 3
    s_cbranch_scc0 K2_SC1
    s_mov_b64 exec, s[88:89]
    v_lshrrev_b32 v164, 21, v140
    v_and_b32 v164, 0x7fc, v164
    ds_read_b32 v164, v164 offset:2048
    s_mov_b64 exec, s[90:91]
    v_lshrrev_b32 v165, 21, v141
    v_and_b32 v165, 0x7fc, v165
    ds_read_b32 v165, v165 offset:2048
    s_mov_b64 exec, s[92:93]
    v_lshrrev_b32 v166, 21, v142
    v_and_b32 v166, 0x7fc, v166
    ds_read_b32 v166, v166 offset:2048
    s_mov_b64 exec, s[94:95]
    v_lshrrev_b32 v167, 21, v143
    v_and_b32 v167, 0x7fc, v167
    ds_read_b32 v167, v167 offset:2048
    s_nop 0
K2_SC1:
    s_mov_b64 exec, -1
    s_add_u32 m0, s97, 93184
    s_nop 0
    buffer_load_dwordx4 v15, s[40:43], s97 offen lds
    s_add_u32 s97, s97, 8192
    s_add_u32 m0, s97, 93184
    s_nop 0
    buffer_load_dwordx4 v15, s[40:43], s97 offen lds
    s_add_u32 s97, s97, 8192
    s_waitcnt lgkmcnt(0)
    s_cmp_gt_u32 s49, 0
    s_cbranch_scc0 K2_SC2
    s_mov_b64 exec, s[64:65]
    v_add_lshl_u32 v152, v152, v72, 4
    ds_write_b64 v152, v[40:41] offset:6656
    ds_write_b32 v152, v128 offset:6664
    s_mov_b64 exec, s[66:67]
    v_add_lshl_u32 v153, v153, v73, 4
    ds_write_b64 v153, v[42:43] offset:6656
    ds_write_b32 v153, v129 offset:6664
    s_mov_b64 exec, s[68:69]
    v_add_lshl_u32 v154, v154, v74, 4
    ds_write_b64 v154, v[44:45] offset:6656
    ds_write_b32 v154, v130 offset:6664
    s_mov_b64 exec, s[70:71]
    v_add_lshl_u32 v155, v155, v75, 4
    ds_write_b64 v155, v[46:47] offset:6656
    ds_write_b32 v155, v131 offset:6664
    s_cmp_gt_u32 s49, 1
    s_cbranch_scc0 K2_SC2
    s_mov_b64 exec, s[72:73]
    v_add_lshl_u32 v156, v156, v76, 4
    ds_write_b64 v156, v[48:49] offset:6656
    ds_write_b32 v156, v132 offset:6664
    s_mov_b64 exec, s[74:75]
    v_add_lshl_u32 v157, v157, v77, 4
    ds_write_b64 v157, v[50:51] offset:6656
    ds_write_b32 v157, v133 offset:6664
    s_mov_b64 exec, s[76:77]
    v_add_lshl_u32 v158, v158, v78, 4
    ds_write_b64 v158, v[52:53] offset:6656
    ds_write_b32 v158, v134 offset:6664
    s_mov_b64 exec, s[78:79]
    v_add_lshl_u32 v159, v159, v79, 4
    ds_write_b64 v159, v[54:55] offset:6656
    ds_write_b32 v159, v135 offset:6664
    s_cmp_gt_u32 s49, 2
    s_cbranch_scc0 K2_SC2
    s_mov_b64 exec, s[80:81]
    v_add_lshl_u32 v160, v160, v80, 4
    ds_write_b64 v160, v[56:57] offset:6656
    ds_write_b32 v160, v136 offset:6664
    s_mov_b64 exec, s[82:83]
    v_add_lshl_u32 v161, v161, v81, 4
    ds_write_b64 v161, v[58:59] offset:6656
    ds_write_b32 v161, v137 offset:6664
    s_mov_b64 exec, s[84:85]
    v_add_lshl_u32 v162, v162, v82, 4
    ds_write_b64 v162, v[60:61] offset:6656
    ds_write_b32 v162, v138 offset:6664
    s_mov_b64 exec, s[86:87]
    v_add_lshl_u32 v163, v163, v83, 4
    ds_write_b64 v163, v[62:63] offset:6656
    ds_write_b32 v163, v139 offset:6664
    s_cmp_gt_u32 s49, 3
    s_cbranch_scc0 K2_SC2
    s_mov_b64 exec, s[88:89]
    v_add_lshl_u32 v164, v164, v84, 4
    ds_write_b64 v164, v[64:65] offset:6656
    ds_write_b32 v164, v140 offset:6664
    s_mov_b64 exec, s[90:91]
    v_add_lshl_u32 v165, v165, v85, 4
    ds_write_b64 v165, v[66:67] offset:6656
    ds_write_b32 v165, v141 offset:6664
    s_mov_b64 exec, s[92:93]
    v_add_lshl_u32 v166, v166, v86, 4
    ds_write_b64 v166, v[68:69] offset:6656
    ds_write_b32 v166, v142 offset:6664
    s_mov_b64 exec, s[94:95]
    v_add_lshl_u32 v167, v167, v87, 4
    ds_write_b64 v167, v[70:71] offset:6656
    ds_write_b32 v167, v143 offset:6664
K2_SC2:
    s_mov_b64 exec, -1
    s_cmp_lt_u32 s48, 5
    s_cbranch_scc0 K2_D3
    s_add_u32 m0, s97, 93184
    s_nop 0
    buffer_load_dwordx4 v15, s[40:43], s97 offen lds
K2_D3:
    s_lshl_b32 s17, s100, 3
    buffer_load_dwordx2 v[26:27], v33, s[44:47], s17 offen sc1
    s_cmp_eq_u32 s50, 0
    s_cbranch_scc0 K2_L1
    v_cmp_gt_u32 vcc, v24, v25
    s_sub_u32 s59, 11, s48
    s_cmp_lt_u32 s48, 4
    v_cndmask_b32 v24, 0, v34, vcc
    s_cselect_b32 s59, s48, s59
    s_nop 0
    v_add_u32_dpp v24, v24, v24 row_shr:1 row_mask:0xf bank_mask:0xf
    s_nop 1
    v_add_u32_dpp v24, v24, v24 row_shr:2 row_mask:0xf bank_mask:0xf
    s_nop 1
    v_add_u32_dpp v24, v24, v24 row_shr:4 row_mask:0xf bank_mask:0xf
    v_cmp_eq_u32 vcc, s59, v24
    s_nop 0
    s_and_b64 vcc, vcc, s[14:15]
    s_ff1_i32_b64 s55, vcc
    s_lshr_b32 s55, s55, 3
K2_L1:
    s_lshl_b32 s60, s55, 3
    v_or3_b32 v180, v180, v181, v182
    v_readlane_b32 s52, v112, s60
    s_add_u32 s60, s60, 7
    v_or3_b32 v183, v183, v184, v185
    v_readlane_b32 s53, v28, s60
    v_or3_b32 v180, v180, v186, v187
    v_or_b32 v180, v180, v183
    s_add_u32 s54, s53, 31
    v_readfirstlane_b32 s51, v180
    s_lshr_b32 s54, s54, 5
    s_lshl_b32 s52, s52, 4
    s_add_u32 s52, s52, 6656
    v_add_u32 v36, s52, v15
    v_lshrrev_b32 v37, 5, v12
    v_lshl_add_u32 v37, v37, 9, s52
    v_and_b32 v38, 31, v12
    v_lshl_add_u32 v39, v38, 2, v37
    v_lshl_add_u32 v37, v38, 1, v37
    v_mov_b32 v38, v12
    v_lshl_add_u32 v8, v13, 4, s52
    v_lshl_add_u32 v9, v13, 3, s52
    v_lshl_add_u32 v10, v14, 2, s52
    v_add_u32 v10, 384, v10
    s_mov_b32 s96, 0
    s_mov_b32 s56, 0
    s_mov_b32 s40, s4
    s_and_b32 s41, s5, 0xffff
    s_mov_b32 s42, 0xc35000
    s_mov_b32 s43, 0x20000
    s_waitcnt lgkmcnt(0)
    v_add_u32 v48, 157696, v15
    s_mov_b32 s60, 0
    s_nop 0
    s_branch K2_PT_T
K2_PT:
    s_sleep 6
    s_mov_b64 exec, vcc
    buffer_load_dwordx2 v[26:27], v33, s[44:47], s17 offen sc1
    s_mov_b64 exec, -1
K2_PT_T:
    s_waitcnt vmcnt(0)
    v_xor_b32 v22, s27, v26
    v_xor_b32 v23, s26, v27
    v_lshrrev_b32 v22, 24, v22
    v_or_b32 v22, v22, v23
    v_cmp_ne_u32 vcc, 0, v22
    s_add_u32 s60, s60, 1
    s_cmp_lg_u64 vcc, 0
    s_cselect_b32 s3, s60, -1
    s_cmp_lt_u32 s3, 1048576
    s_nop 0
    s_cbranch_scc1 K2_PT
    s_barrier
    s_cmp_eq_u32 s54, 0
    s_cbranch_scc1 K2_LOOP_CHECK
    ds_read_b96 v[40:42], v36
    v_cmp_gt_u32 vcc, s53, v38
    v_add_u32 v36, 1024, v36
    v_add_u32 v38, 64, v38
    s_add_u32 s96, s96, 64
    s_waitcnt lgkmcnt(0)
    v_bfe_u32 v47, v42, 19, 4
    v_cndmask_b32 v42, -1, v42, vcc
    ds_write_b16 v37, v42
    ds_read2_b64 v[20:23], v9 offset0:0 offset1:4
    v_lshlrev_b32 v44, 16, v40
    v_and_b32 v45, s57, v40
    v_mul_f32 v64, v44, v44
    v_mul_f32 v65, v45, v45
    v_mul_f32 v66, v41, v41
    v_lshlrev_b32 v47, v47, 1
    v_cvt_pk_bf16_f32 v64, 0, v64
    v_cvt_pk_bf16_f32 v65, 0, v65
    v_cvt_pk_bf16_f32 v66, 0, v66
    v_cndmask_b32 v47, 0, v47, vcc
    v_add_f32 v68, v64, v65
    v_add_f32 v68, v68, v66
    s_waitcnt lgkmcnt(0)
    v_mad_u32_u16 v28, v20, s58, v1
    buffer_load_dwordx4 v[88:91], v28, s[28:31], 0 offen
    v_mad_u32_u16 v29, v20, s58, v1 op_sel:[1,0,0,0]
    buffer_load_dwordx4 v[92:95], v29, s[28:31], 0 offen
    v_mad_u32_u16 v30, v21, s58, v1
    buffer_load_dwordx4 v[96:99], v30, s[28:31], 0 offen
    v_mad_u32_u16 v31, v21, s58, v1 op_sel:[1,0,0,0]
    buffer_load_dwordx4 v[100:103], v31, s[28:31], 0 offen
    v_mad_u32_u16 v32, v22, s58, v1
    buffer_load_dwordx4 v[104:107], v32, s[28:31], 0 offen
    v_mad_u32_u16 v33, v22, s58, v1 op_sel:[1,0,0,0]
    buffer_load_dwordx4 v[108:111], v33, s[28:31], 0 offen
    v_mad_u32_u16 v34, v23, s58, v1
    buffer_load_dwordx4 v[112:115], v34, s[28:31], 0 offen
    v_mad_u32_u16 v35, v23, s58, v1 op_sel:[1,0,0,0]
    buffer_load_dwordx4 v[116:119], v35, s[28:31], 0 offen
    buffer_load_dwordx4 v[120:123], v28, s[28:31], 0 offen offset:256
    buffer_load_dwordx4 v[124:127], v29, s[28:31], 0 offen offset:256
    buffer_load_dwordx4 v[128:131], v30, s[28:31], 0 offen offset:256
    buffer_load_dwordx4 v[132:135], v31, s[28:31], 0 offen offset:256
    buffer_load_dwordx4 v[136:139], v32, s[28:31], 0 offen offset:256
    buffer_load_dwordx4 v[140:143], v33, s[28:31], 0 offen offset:256
    buffer_load_dwordx4 v[144:147], v34, s[28:31], 0 offen offset:256
    buffer_load_dwordx4 v[148:151], v35, s[28:31], 0 offen offset:256
    v_mad_u32_u16 v14, v20, s58, v2
    buffer_load_dword v152, v14, s[28:31], 0 offen offset:512
    buffer_load_dword v153, v14, s[28:31], 0 offen offset:576
    v_mad_u32_u16 v15, v20, s58, v2 op_sel:[1,0,0,0]
    buffer_load_dword v154, v15, s[28:31], 0 offen offset:512
    buffer_load_dword v155, v15, s[28:31], 0 offen offset:576
    v_mad_u32_u16 v14, v21, s58, v2
    buffer_load_dword v156, v14, s[28:31], 0 offen offset:512
    buffer_load_dword v157, v14, s[28:31], 0 offen offset:576
    v_mad_u32_u16 v15, v21, s58, v2 op_sel:[1,0,0,0]
    buffer_load_dword v158, v15, s[28:31], 0 offen offset:512
    buffer_load_dword v159, v15, s[28:31], 0 offen offset:576
    v_mad_u32_u16 v14, v22, s58, v2
    buffer_load_dword v160, v14, s[28:31], 0 offen offset:512
    buffer_load_dword v161, v14, s[28:31], 0 offen offset:576
    v_mad_u32_u16 v15, v22, s58, v2 op_sel:[1,0,0,0]
    buffer_load_dword v162, v15, s[28:31], 0 offen offset:512
    buffer_load_dword v163, v15, s[28:31], 0 offen offset:576
    v_mad_u32_u16 v14, v23, s58, v2
    buffer_load_dword v164, v14, s[28:31], 0 offen offset:512
    buffer_load_dword v165, v14, s[28:31], 0 offen offset:576
    v_mad_u32_u16 v15, v23, s58, v2 op_sel:[1,0,0,0]
    buffer_load_dword v166, v15, s[28:31], 0 offen offset:512
    buffer_load_dword v167, v15, s[28:31], 0 offen offset:576
    ds_write_b16 v37, v47 offset:64
    v_cvt_pk_bf16_f32 v68, 0, v68
    v_add_f32 v68, 0x322bcc77, v68
    v_cvt_pk_bf16_f32 v68, 0, v68
    v_sqrt_f32 v68, v68
    s_nop 0
    v_cvt_pk_bf16_f32 v68, 0, v68
    v_cndmask_b32 v68, 1.0, v68, vcc
    v_rcp_f32 v69, v68
    v_mul_f32 v47, s61, v68
    v_lshrrev_b32 v64, 11, v68
    v_cvt_pk_bf16_f32 v47, 0, v47
    v_subrev_u32 v64, 464896, v64
    v_cmp_gt_f32 vcc, 0x40a00000, v68
    v_mul_f32 v47, s62, v47
    v_min_u32 v64, 64480, v64
    v_cvt_pk_bf16_f32 v47, 0, v47
    v_add_u32 v64, 93184, v64
    v_mul_f32 v47, 0.15915494, v47
    ds_write_b32 v39, v64 offset:384
    v_cos_f32 v47, v47
    v_mul_f32 v44, v44, v69
    v_mul_f32 v45, v45, v69
    v_mul_f32 v41, v41, v69
    v_cvt_pk_bf16_f32 v47, 0, v47
    v_cvt_pk_bf16_f32 v44, 0, v44
    v_cvt_pk_bf16_f32 v45, 0, v45
    v_cvt_pk_bf16_f32 v41, 0, v41
    v_add_f32 v47, 1.0, v47
    v_cvt_pk_bf16_f32 v47, 0, v47
    v_mul_f32 v70, 0.5, v47
    v_cndmask_b32 v70, 0, v70, vcc
    v_mul_f32 v44, v44, v70
    v_mul_f32 v45, v45, v70
    v_mul_f32 v41, v41, v70
    v_cvt_pk_bf16_f32 v44, v44, v45
    v_cvt_pk_bf16_f32 v46, v41, v70
    ds_write_b16 v37, v44 offset:192
    ds_write_b16_d16_hi v37, v44 offset:256
    ds_write_b16_d16_hi v37, v46 offset:128
    ds_write_b16 v37, v46 offset:320
    v_add_u32 v37, 1024, v37
    v_add_u32 v39, 1024, v39
    ds_read2_b32 v[12:13], v10 offset0:0 offset1:16
    ds_read_b128 v[16:19], v8 offset:64
    ds_read_b128 v[76:79], v8 offset:192
    ds_read_b128 v[80:83], v8 offset:256
    ds_read_b128 v[84:87], v8 offset:320
    ds_read2_b64 v[20:23], v9 offset0:64 offset1:68
    s_waitcnt lgkmcnt(0)
    v_add_u32 v12, v12, v4
    v_add_u32 v13, v13, v4
    v_pk_lshlrev_b16 v16, v3, v16
    v_pk_lshlrev_b16 v17, v3, v17
    v_pk_lshlrev_b16 v18, v3, v18
    v_pk_lshlrev_b16 v19, v3, v19
    v_pk_ashrrev_i16 v16, 15, v16 op_sel_hi:[0,1]
    v_pk_ashrrev_i16 v17, 15, v17 op_sel_hi:[0,1]
    v_pk_ashrrev_i16 v18, 15, v18 op_sel_hi:[0,1]
    v_pk_ashrrev_i16 v19, 15, v19 op_sel_hi:[0,1]
    v_and_b32 v76, v76, v16
    v_and_b32 v77, v77, v17
    v_and_b32 v78, v78, v18
    v_and_b32 v79, v79, v19
    v_and_b32 v80, v80, v16
    v_and_b32 v81, v81, v17
    v_and_b32 v82, v82, v18
    v_and_b32 v83, v83, v19
    v_and_b32 v84, v84, v16
    v_and_b32 v85, v85, v17
    v_and_b32 v86, v86, v18
    v_and_b32 v87, v87, v19
    ds_read_b64 v[24:25], v12
    ds_read_b64 v[26:27], v13
    ds_read_b128 v[168:171], v48 offset:0
    ds_read_b128 v[172:175], v48 offset:1024
    ds_read_b128 v[176:179], v48 offset:2048
    ds_read_b128 v[180:183], v48 offset:3072
    ds_read_b128 v[184:187], v48 offset:4096
    ds_read_b128 v[188:191], v48 offset:5120
    s_waitcnt lgkmcnt(0)
    v_mfma_f32_16x16x16_bf16 v[48:51], v[24:25], v[186:187], 0
    v_mfma_f32_16x16x16_bf16 v[52:55], v[26:27], v[186:187], 0
    v_mfma_f32_16x16x16_bf16 v[56:59], v[24:25], v[178:179], 0
    v_mfma_f32_16x16x16_bf16 v[60:63], v[26:27], v[178:179], 0
    s_nop 7
K2_LOOP:
    s_bitcmp1_b32 s56, 0
    s_cbranch_scc1 K2_NOFIN
    s_cmp_lt_u32 s96, s53
    s_cbranch_scc0 K2_NOFIN
    ds_read_b96 v[40:42], v36
    v_cmp_gt_u32 vcc, s53, v38
    v_add_u32 v36, 1024, v36
    v_add_u32 v38, 64, v38
    s_add_u32 s96, s96, 64
    s_waitcnt lgkmcnt(0)
    v_bfe_u32 v47, v42, 19, 4
    v_cndmask_b32 v42, -1, v42, vcc
    ds_write_b16 v37, v42
    v_lshlrev_b32 v44, 16, v40
    v_and_b32 v45, s57, v40
    v_mul_f32 v64, v44, v44
    v_mul_f32 v65, v45, v45
    v_mul_f32 v66, v41, v41
    v_lshlrev_b32 v47, v47, 1
    v_cvt_pk_bf16_f32 v64, 0, v64
    v_cvt_pk_bf16_f32 v65, 0, v65
    v_cvt_pk_bf16_f32 v66, 0, v66
    v_cndmask_b32 v47, 0, v47, vcc
    v_add_f32 v68, v64, v65
    v_add_f32 v68, v68, v66
    ds_write_b16 v37, v47 offset:64
    v_cvt_pk_bf16_f32 v68, 0, v68
    v_add_f32 v68, 0x322bcc77, v68
    v_cvt_pk_bf16_f32 v68, 0, v68
    v_sqrt_f32 v68, v68
    s_nop 0
    v_cvt_pk_bf16_f32 v68, 0, v68
    v_cndmask_b32 v68, 1.0, v68, vcc
    v_rcp_f32 v69, v68
    v_mul_f32 v47, s61, v68
    v_lshrrev_b32 v64, 11, v68
    v_cvt_pk_bf16_f32 v47, 0, v47
    v_subrev_u32 v64, 464896, v64
    v_cmp_gt_f32 vcc, 0x40a00000, v68
    v_mul_f32 v47, s62, v47
    v_min_u32 v64, 64480, v64
    v_cvt_pk_bf16_f32 v47, 0, v47
    v_add_u32 v64, 93184, v64
    v_mul_f32 v47, 0.15915494, v47
    ds_write_b32 v39, v64 offset:384
    v_cos_f32 v47, v47
    v_mul_f32 v44, v44, v69
    v_mul_f32 v45, v45, v69
    v_mul_f32 v41, v41, v69
    v_cvt_pk_bf16_f32 v47, 0, v47
    v_cvt_pk_bf16_f32 v44, 0, v44
    v_cvt_pk_bf16_f32 v45, 0, v45
    v_cvt_pk_bf16_f32 v41, 0, v41
    v_add_f32 v47, 1.0, v47
    v_cvt_pk_bf16_f32 v47, 0, v47
    v_mul_f32 v70, 0.5, v47
    v_cndmask_b32 v70, 0, v70, vcc
    v_mul_f32 v44, v44, v70
    v_mul_f32 v45, v45, v70
    v_mul_f32 v41, v41, v70
    v_cvt_pk_bf16_f32 v44, v44, v45
    v_cvt_pk_bf16_f32 v46, v41, v70
    ds_write_b16 v37, v44 offset:192
    ds_write_b16_d16_hi v37, v44 offset:256
    ds_write_b16_d16_hi v37, v46 offset:128
    ds_write_b16 v37, v46 offset:320
    v_add_u32 v37, 1024, v37
    v_add_u32 v39, 1024, v39
    s_nop 1
K2_NOFIN:
    ds_read_b128 v[72:75], v8 offset:128
    ds_read2_b32 v[12:13], v10 offset0:128 offset1:144
    ds_read_b32 v7, v6 offset:4160
    s_add_u32 s56, s56, 1
    s_waitcnt vmcnt(24)
    v_mul_f32 v48, v91, v48
    v_mul_f32 v49, v95, v49
    v_mul_f32 v50, v99, v50
    v_mul_f32 v51, v103, v51
    v_mfma_f32_16x16x16_bf16 v[64:67], v[24:25], v[176:177], 0
    v_mul_f32 v52, v107, v52
    v_mul_f32 v53, v111, v53
    v_mul_f32 v54, v115, v54
    v_mul_f32 v55, v119, v55
    v_mfma_f32_16x16x16_bf16 v[68:71], v[26:27], v[176:177], 0
    s_waitcnt lgkmcnt(0)
    v_and_b32 v72, v72, v16
    v_and_b32 v73, v73, v17
    v_and_b32 v74, v74, v18
    v_and_b32 v75, v75, v19
    v_smfmac_f32_16x16x64_bf16 v[212:215], v[76:79], v[48:55], v11
    v_add_u32 v12, v12, v4
    v_add_u32 v13, v13, v4
    ds_write_b32 v5, v20 offset:4160
    v_cmp_gt_u32 vcc, v20, v7
    s_setprio 1
    s_bitcmp1_b32 vcc_lo, 0
    s_cbranch_scc0 K2_PR
    s_setprio 0
K2_PR:
    v_mul_f32 v40, v88, v56
    v_mul_f32 v41, v92, v57
    v_smfmac_f32_16x16x64_bf16 v[228:231], v[80:83], v[48:55], v11
    v_mul_f32 v42, v96, v58
    v_mul_f32 v43, v100, v59
    v_mul_f32 v44, v104, v60
    v_mul_f32 v45, v108, v61
    v_smfmac_f32_16x16x64_bf16 v[244:247], v[84:87], v[48:55], v11
    v_mul_f32 v46, v112, v62
    v_mul_f32 v47, v116, v63
    v_mfma_f32_16x16x16_bf16 v[48:51], v[24:25], v[184:185], 0
    v_mfma_f32_16x16x16_bf16 v[52:55], v[26:27], v[184:185], 0
    v_smfmac_f32_16x16x64_bf16 v[212:215], v[72:75], v[40:47], v11
    v_mul_f32 v40, v89, v56
    v_mul_f32 v41, v93, v57
    v_mul_f32 v42, v97, v58
    v_mul_f32 v43, v101, v59
    v_mul_f32 v44, v105, v60
    v_mul_f32 v45, v109, v61
    v_mul_f32 v46, v113, v62
    v_mul_f32 v47, v117, v63
    v_lshlrev_b64 v[88:89], 16, v[88:89]
    v_lshlrev_b64 v[92:93], 16, v[92:93]
    v_smfmac_f32_16x16x64_bf16 v[228:231], v[72:75], v[40:47], v11
    v_lshlrev_b64 v[96:97], 16, v[96:97]
    v_lshlrev_b64 v[100:101], 16, v[100:101]
    v_lshlrev_b64 v[104:105], 16, v[104:105]
    v_lshlrev_b64 v[108:109], 16, v[108:109]
    v_lshlrev_b64 v[112:113], 16, v[112:113]
    v_lshlrev_b64 v[116:117], 16, v[116:117]
    v_mul_f32 v56, v90, v56
    v_mul_f32 v57, v94, v57
    v_mul_f32 v58, v98, v58
    v_mul_f32 v59, v102, v59
    v_mul_f32 v60, v106, v60
    v_mul_f32 v61, v110, v61
    v_mul_f32 v62, v114, v62
    v_mul_f32 v63, v118, v63
    v_lshlrev_b64 v[90:91], 16, v[90:91]
    v_lshlrev_b64 v[94:95], 16, v[94:95]
    v_smfmac_f32_16x16x64_bf16 v[244:247], v[72:75], v[56:63], v11
    v_lshlrev_b64 v[98:99], 16, v[98:99]
    v_lshlrev_b64 v[102:103], 16, v[102:103]
    v_lshlrev_b64 v[106:107], 16, v[106:107]
    v_lshlrev_b64 v[110:111], 16, v[110:111]
    v_lshlrev_b64 v[114:115], 16, v[114:115]
    v_lshlrev_b64 v[118:119], 16, v[118:119]
    v_mul_f32 v40, v88, v64
    v_mfma_f32_16x16x16_bf16 v[56:59], v[24:25], v[182:183], 0
    v_mul_f32 v41, v92, v65
    v_mul_f32 v42, v96, v66
    v_mul_f32 v43, v100, v67
    v_mul_f32 v44, v104, v68
    v_mfma_f32_16x16x16_bf16 v[60:63], v[26:27], v[182:183], 0
    v_mul_f32 v45, v108, v69
    v_mul_f32 v46, v112, v70
    v_mul_f32 v47, v116, v71
    v_mul_f32 v48, v91, v48
    v_mul_f32 v49, v95, v49
    v_smfmac_f32_16x16x64_bf16 v[208:211], v[72:75], v[40:47], v11
    v_mul_f32 v50, v99, v50
    v_mul_f32 v51, v103, v51
    v_mul_f32 v52, v107, v52
    v_mul_f32 v53, v111, v53
    v_mul_f32 v54, v115, v54
    v_mul_f32 v55, v119, v55
    v_mul_f32 v40, v89, v64
    v_mul_f32 v41, v93, v65
    v_smfmac_f32_16x16x64_bf16 v[208:211], v[76:79], v[48:55], v11
    v_mul_f32 v42, v97, v66
    v_mul_f32 v43, v101, v67
    v_mul_f32 v44, v105, v68
    v_mul_f32 v45, v109, v69
    v_smfmac_f32_16x16x64_bf16 v[224:227], v[80:83], v[48:55], v11
    v_mul_f32 v46, v113, v70
    v_mul_f32 v47, v117, v71
    v_mul_f32 v64, v90, v64
    v_mul_f32 v65, v94, v65
    v_smfmac_f32_16x16x64_bf16 v[240:243], v[84:87], v[48:55], v11
    v_mul_f32 v66, v98, v66
    v_mul_f32 v67, v102, v67
    v_mul_f32 v68, v106, v68
    v_mul_f32 v69, v110, v69
    v_mfma_f32_16x16x16_bf16 v[48:51], v[24:25], v[190:191], 0
    v_mul_f32 v70, v114, v70
    v_mul_f32 v71, v118, v71
    s_cmp_ge_u32 s56, s54
    s_cbranch_scc1 K2_B0_W
    v_mad_u32_u16 v28, v20, s58, v1
    buffer_load_dwordx4 v[88:91], v28, s[28:31], 0 offen
    v_mad_u32_u16 v29, v20, s58, v1 op_sel:[1,0,0,0]
    buffer_load_dwordx4 v[92:95], v29, s[28:31], 0 offen
    v_mad_u32_u16 v30, v21, s58, v1
    buffer_load_dwordx4 v[96:99], v30, s[28:31], 0 offen
    v_mad_u32_u16 v31, v21, s58, v1 op_sel:[1,0,0,0]
    buffer_load_dwordx4 v[100:103], v31, s[28:31], 0 offen
    v_mad_u32_u16 v32, v22, s58, v1
    buffer_load_dwordx4 v[104:107], v32, s[28:31], 0 offen
    v_mad_u32_u16 v33, v22, s58, v1 op_sel:[1,0,0,0]
    buffer_load_dwordx4 v[108:111], v33, s[28:31], 0 offen
    v_mad_u32_u16 v34, v23, s58, v1
    buffer_load_dwordx4 v[112:115], v34, s[28:31], 0 offen
    v_mad_u32_u16 v35, v23, s58, v1 op_sel:[1,0,0,0]
    buffer_load_dwordx4 v[116:119], v35, s[28:31], 0 offen
K2_B0:
    s_waitcnt vmcnt(24)
    v_mfma_f32_16x16x16_bf16 v[52:55], v[26:27], v[190:191], 0
    v_smfmac_f32_16x16x64_bf16 v[224:227], v[72:75], v[40:47], v11
    v_mul_f32 v40, v120, v56
    v_mul_f32 v41, v124, v57
    v_mul_f32 v42, v128, v58
    v_mul_f32 v43, v132, v59
    v_smfmac_f32_16x16x64_bf16 v[240:243], v[72:75], v[64:71], v11
    v_mul_f32 v44, v136, v60
    v_mul_f32 v45, v140, v61
    v_mul_f32 v46, v144, v62
    v_mul_f32 v47, v148, v63
    v_mfma_f32_16x16x16_bf16 v[64:67], v[24:25], v[180:181], 0
    v_mul_f32 v48, v123, v48
    v_mul_f32 v49, v127, v49
    v_mul_f32 v50, v131, v50
    v_mul_f32 v51, v135, v51
    v_mfma_f32_16x16x16_bf16 v[68:71], v[26:27], v[180:181], 0
    v_mul_f32 v52, v139, v52
    v_mul_f32 v53, v143, v53
    v_mul_f32 v54, v147, v54
    v_mul_f32 v55, v151, v55
    v_smfmac_f32_16x16x64_bf16 v[220:223], v[72:75], v[40:47], v11
    v_mul_f32 v40, v121, v56
    v_mul_f32 v41, v125, v57
    v_mul_f32 v42, v129, v58
    v_mul_f32 v43, v133, v59
    v_smfmac_f32_16x16x64_bf16 v[220:223], v[76:79], v[48:55], v11
    v_mul_f32 v44, v137, v60
    v_mul_f32 v45, v141, v61
    v_mul_f32 v46, v145, v62
    v_mul_f32 v47, v149, v63
    v_smfmac_f32_16x16x64_bf16 v[236:239], v[80:83], v[48:55], v11
    v_lshlrev_b64 v[120:121], 16, v[120:121]
    v_lshlrev_b64 v[124:125], 16, v[124:125]
    v_lshlrev_b64 v[128:129], 16, v[128:129]
    v_lshlrev_b64 v[132:133], 16, v[132:133]
    v_smfmac_f32_16x16x64_bf16 v[252:255], v[84:87], v[48:55], v11
    v_lshlrev_b64 v[136:137], 16, v[136:137]
    v_lshlrev_b64 v[140:141], 16, v[140:141]
    v_lshlrev_b64 v[144:145], 16, v[144:145]
    v_lshlrev_b64 v[148:149], 16, v[148:149]
    v_mfma_f32_16x16x16_bf16 v[48:51], v[24:25], v[188:189], 0
    v_mul_f32 v56, v122, v56
    v_mul_f32 v57, v126, v57
    v_mul_f32 v58, v130, v58
    v_mul_f32 v59, v134, v59
    v_mfma_f32_16x16x16_bf16 v[52:55], v[26:27], v[188:189], 0
    v_mul_f32 v60, v138, v60
    v_mul_f32 v61, v142, v61
    v_mul_f32 v62, v146, v62
    v_mul_f32 v63, v150, v63
    v_smfmac_f32_16x16x64_bf16 v[236:239], v[72:75], v[40:47], v11
    v_lshlrev_b64 v[122:123], 16, v[122:123]
    v_lshlrev_b64 v[126:127], 16, v[126:127]
    v_lshlrev_b64 v[130:131], 16, v[130:131]
    v_lshlrev_b64 v[134:135], 16, v[134:135]
    v_smfmac_f32_16x16x64_bf16 v[252:255], v[72:75], v[56:63], v11
    v_lshlrev_b64 v[138:139], 16, v[138:139]
    v_lshlrev_b64 v[142:143], 16, v[142:143]
    v_lshlrev_b64 v[146:147], 16, v[146:147]
    v_lshlrev_b64 v[150:151], 16, v[150:151]
    v_mul_f32 v40, v120, v64
    v_mfma_f32_16x16x16_bf16 v[56:59], v[24:25], v[170:171], 0
    v_mul_f32 v41, v124, v65
    v_mul_f32 v42, v128, v66
    v_mul_f32 v43, v132, v67
    v_mul_f32 v44, v136, v68
    v_mfma_f32_16x16x16_bf16 v[60:63], v[26:27], v[170:171], 0
    v_mul_f32 v45, v140, v69
    v_mul_f32 v46, v144, v70
    v_mul_f32 v47, v148, v71
    v_mul_f32 v48, v123, v48
    v_mul_f32 v49, v127, v49
    v_smfmac_f32_16x16x64_bf16 v[216:219], v[72:75], v[40:47], v11
    v_mul_f32 v50, v131, v50
    v_mul_f32 v51, v135, v51
    v_mul_f32 v52, v139, v52
    v_mul_f32 v53, v143, v53
    v_mul_f32 v54, v147, v54
    v_mul_f32 v55, v151, v55
    v_mul_f32 v40, v121, v64
    v_mul_f32 v41, v125, v65
    v_smfmac_f32_16x16x64_bf16 v[216:219], v[76:79], v[48:55], v11
    v_mul_f32 v42, v129, v66
    v_mul_f32 v43, v133, v67
    v_mul_f32 v44, v137, v68
    v_mul_f32 v45, v141, v69
    v_smfmac_f32_16x16x64_bf16 v[232:235], v[80:83], v[48:55], v11
    v_mul_f32 v46, v145, v70
    v_mul_f32 v47, v149, v71
    v_mul_f32 v64, v122, v64
    v_mul_f32 v65, v126, v65
    v_smfmac_f32_16x16x64_bf16 v[248:251], v[84:87], v[48:55], v11
    v_mul_f32 v66, v130, v66
    v_mul_f32 v67, v134, v67
    v_mul_f32 v68, v138, v68
    v_mul_f32 v69, v142, v69
    v_mfma_f32_16x16x16_bf16 v[48:51], v[24:25], v[174:175], 0
    v_mul_f32 v70, v146, v70
    v_mul_f32 v71, v150, v71
    s_cmp_ge_u32 s56, s54
    s_cbranch_scc1 K2_B1
    buffer_load_dwordx4 v[120:123], v28, s[28:31], 0 offen offset:256
    buffer_load_dwordx4 v[124:127], v29, s[28:31], 0 offen offset:256
    buffer_load_dwordx4 v[128:131], v30, s[28:31], 0 offen offset:256
    buffer_load_dwordx4 v[132:135], v31, s[28:31], 0 offen offset:256
    buffer_load_dwordx4 v[136:139], v32, s[28:31], 0 offen offset:256
    buffer_load_dwordx4 v[140:143], v33, s[28:31], 0 offen offset:256
    buffer_load_dwordx4 v[144:147], v34, s[28:31], 0 offen offset:256
    buffer_load_dwordx4 v[148:151], v35, s[28:31], 0 offen offset:256
K2_B1:
    ds_read_b128 v[16:19], v8 offset:576
    ds_read_b128 v[76:79], v8 offset:704
    ds_read_b128 v[80:83], v8 offset:768
    ds_read_b128 v[84:87], v8 offset:832
    s_waitcnt vmcnt(16)
    v_mul_f32 v56, v152, v56
    v_mul_f32 v57, v154, v57
    v_mfma_f32_16x16x16_bf16 v[52:55], v[26:27], v[174:175], 0
    v_mul_f32 v58, v156, v58
    v_mul_f32 v59, v158, v59
    v_mul_f32 v60, v160, v60
    v_mul_f32 v61, v162, v61
    v_smfmac_f32_16x16x64_bf16 v[232:235], v[72:75], v[40:47], v11
    v_mul_f32 v62, v164, v62
    v_mul_f32 v63, v166, v63
    v_mfma_f32_16x16x16_bf16 v[40:43], v[24:25], v[172:173], 0
    v_mfma_f32_16x16x16_bf16 v[44:47], v[26:27], v[172:173], 0
    v_smfmac_f32_16x16x64_bf16 v[248:251], v[72:75], v[64:71], v11
    v_mfma_f32_16x16x16_bf16 v[64:67], v[24:25], v[168:169], 0
    v_mfma_f32_16x16x16_bf16 v[68:71], v[26:27], v[168:169], 0
    ds_read_b64 v[24:25], v12
    ds_read_b64 v[26:27], v13
    s_waitcnt lgkmcnt(2)
    v_mul_f32 v48, v153, v48
    v_pk_lshlrev_b16 v16, v3, v16
    v_mul_f32 v49, v155, v49
    v_pk_lshlrev_b16 v17, v3, v17
    v_smfmac_f32_16x16x64_bf16 v[196:199], v[72:75], v[56:63], v11
    v_mul_f32 v50, v157, v50
    v_pk_lshlrev_b16 v18, v3, v18
    v_mul_f32 v51, v159, v51
    v_pk_lshlrev_b16 v19, v3, v19
    v_mul_f32 v52, v161, v52
    v_pk_ashrrev_i16 v16, 15, v16 op_sel_hi:[0,1]
    v_mul_f32 v53, v163, v53
    v_pk_ashrrev_i16 v17, 15, v17 op_sel_hi:[0,1]
    v_mul_f32 v54, v165, v54
    v_pk_ashrrev_i16 v18, 15, v18 op_sel_hi:[0,1]
    v_mul_f32 v55, v167, v55
    v_pk_ashrrev_i16 v19, 15, v19 op_sel_hi:[0,1]
    s_waitcnt lgkmcnt(0)
    v_lshlrev_b64 v[152:153], 16, v[152:153]
    v_smfmac_f32_16x16x64_bf16 v[204:207], v[72:75], v[48:55], v11
    v_and_b32 v76, v76, v16
    v_lshlrev_b64 v[154:155], 16, v[154:155]
    v_and_b32 v77, v77, v17
    v_lshlrev_b64 v[156:157], 16, v[156:157]
    v_mfma_f32_16x16x16_bf16 v[48:51], v[24:25], v[186:187], 0
    v_and_b32 v78, v78, v18
    v_lshlrev_b64 v[158:159], 16, v[158:159]
    v_and_b32 v79, v79, v19
    v_lshlrev_b64 v[160:161], 16, v[160:161]
    v_mfma_f32_16x16x16_bf16 v[52:55], v[26:27], v[186:187], 0
    v_and_b32 v80, v80, v16
    v_lshlrev_b64 v[162:163], 16, v[162:163]
    v_and_b32 v81, v81, v17
    v_lshlrev_b64 v[164:165], 16, v[164:165]
    v_mfma_f32_16x16x16_bf16 v[56:59], v[24:25], v[178:179], 0
    v_and_b32 v82, v82, v18
    v_lshlrev_b64 v[166:167], 16, v[166:167]
    v_and_b32 v83, v83, v19
    v_mul_f32 v64, v152, v64
    v_mfma_f32_16x16x16_bf16 v[60:63], v[26:27], v[178:179], 0
    v_and_b32 v84, v84, v16
    v_mul_f32 v65, v154, v65
    v_and_b32 v85, v85, v17
    v_mul_f32 v66, v156, v66
    v_and_b32 v86, v86, v18
    v_mul_f32 v67, v158, v67
    v_and_b32 v87, v87, v19
    v_mul_f32 v68, v160, v68
    v_mul_f32 v69, v162, v69
    v_mul_f32 v70, v164, v70
    v_mul_f32 v71, v166, v71
    v_mul_f32 v40, v153, v40
    v_mul_f32 v41, v155, v41
    v_smfmac_f32_16x16x64_bf16 v[192:195], v[72:75], v[64:71], v11
    v_mul_f32 v42, v157, v42
    v_mul_f32 v43, v159, v43
    v_mul_f32 v44, v161, v44
    v_mul_f32 v45, v163, v45
    v_mul_f32 v46, v165, v46
    v_mul_f32 v47, v167, v47
    s_cmp_ge_u32 s56, s54
    s_cbranch_scc1 K2_B2
    v_mad_u32_u16 v14, v20, s58, v2
    buffer_load_dword v152, v14, s[28:31], 0 offen offset:512
    buffer_load_dword v153, v14, s[28:31], 0 offen offset:576
    v_mad_u32_u16 v15, v20, s58, v2 op_sel:[1,0,0,0]
    buffer_load_dword v154, v15, s[28:31], 0 offen offset:512
    buffer_load_dword v155, v15, s[28:31], 0 offen offset:576
    v_mad_u32_u16 v14, v21, s58, v2
    buffer_load_dword v156, v14, s[28:31], 0 offen offset:512
    buffer_load_dword v157, v14, s[28:31], 0 offen offset:576
    v_mad_u32_u16 v15, v21, s58, v2 op_sel:[1,0,0,0]
    buffer_load_dword v158, v15, s[28:31], 0 offen offset:512
    buffer_load_dword v159, v15, s[28:31], 0 offen offset:576
    v_mad_u32_u16 v14, v22, s58, v2
    buffer_load_dword v160, v14, s[28:31], 0 offen offset:512
    buffer_load_dword v161, v14, s[28:31], 0 offen offset:576
    v_mad_u32_u16 v15, v22, s58, v2 op_sel:[1,0,0,0]
    buffer_load_dword v162, v15, s[28:31], 0 offen offset:512
    buffer_load_dword v163, v15, s[28:31], 0 offen offset:576
    v_mad_u32_u16 v14, v23, s58, v2
    buffer_load_dword v164, v14, s[28:31], 0 offen offset:512
    buffer_load_dword v165, v14, s[28:31], 0 offen offset:576
    v_mad_u32_u16 v15, v23, s58, v2 op_sel:[1,0,0,0]
    buffer_load_dword v166, v15, s[28:31], 0 offen offset:512
    buffer_load_dword v167, v15, s[28:31], 0 offen offset:576
K2_B2:
    ds_read2_b64 v[20:23], v9 offset0:128 offset1:132
    v_smfmac_f32_16x16x64_bf16 v[200:203], v[72:75], v[40:47], v11
    v_add_u32 v8, 512, v8
    v_add_u32 v9, 512, v9
    v_add_u32 v10, 512, v10
    s_nop 4
K2_LOOP_CHECK:
    s_cmp_lt_u32 s56, s54
    s_cbranch_scc1 K2_LOOP
    s_cmp_eq_u32 s51, 0
    s_cbranch_scc1 K2_EPI
    s_add_u32 s50, s50, s98
    s_mov_b32 s99, 0
    s_branch K2_AGAIN
K2_RETRY:
    s_mov_b32 s98, 16
K2_AGAIN:
    s_setprio 0
    s_waitcnt vmcnt(0) lgkmcnt(0)
    s_barrier
    s_branch K2_ROUND
K2_B0_W:
    s_mul_i32 s59, s100, 98
    s_movk_i32 s60, 98
    v_mov_b32 v33, 0x7f000000
    v_lshlrev_b32 v32, 2, v4
    v_add3_u32 v32, v32, s55, 0
    v_cmp_gt_u32 vcc, s60, v32
    v_add_lshl_u32 v32, v32, s59, 9
    v_add_u32 v32, v32, v2
    v_cndmask_b32 v28, v33, v32, vcc
    buffer_load_dword v88, v28, s[40:43], 0 offen offset:0
    buffer_load_dword v89, v28, s[40:43], 0 offen offset:64
    buffer_load_dword v90, v28, s[40:43], 0 offen offset:128
    buffer_load_dword v91, v28, s[40:43], 0 offen offset:192
    buffer_load_dword v92, v28, s[40:43], 0 offen offset:256
    buffer_load_dword v93, v28, s[40:43], 0 offen offset:320
    buffer_load_dword v94, v28, s[40:43], 0 offen offset:384
    buffer_load_dword v95, v28, s[40:43], 0 offen offset:448
    v_lshlrev_b32 v32, 2, v4
    v_add3_u32 v32, v32, s55, 8
    v_cmp_gt_u32 vcc, s60, v32
    v_add_lshl_u32 v32, v32, s59, 9
    v_add_u32 v32, v32, v2
    v_cndmask_b32 v29, v33, v32, vcc
    buffer_load_dword v96, v29, s[40:43], 0 offen offset:0
    buffer_load_dword v97, v29, s[40:43], 0 offen offset:64
    buffer_load_dword v98, v29, s[40:43], 0 offen offset:128
    buffer_load_dword v99, v29, s[40:43], 0 offen offset:192
    buffer_load_dword v100, v29, s[40:43], 0 offen offset:256
    buffer_load_dword v101, v29, s[40:43], 0 offen offset:320
    buffer_load_dword v102, v29, s[40:43], 0 offen offset:384
    buffer_load_dword v103, v29, s[40:43], 0 offen offset:448
    v_lshlrev_b32 v32, 2, v4
    v_add3_u32 v32, v32, s55, 16
    v_cmp_gt_u32 vcc, s60, v32
    v_add_lshl_u32 v32, v32, s59, 9
    v_add_u32 v32, v32, v2
    v_cndmask_b32 v30, v33, v32, vcc
    buffer_load_dword v104, v30, s[40:43], 0 offen offset:0
    buffer_load_dword v105, v30, s[40:43], 0 offen offset:64
    buffer_load_dword v106, v30, s[40:43], 0 offen offset:128
    buffer_load_dword v107, v30, s[40:43], 0 offen offset:192
    buffer_load_dword v108, v30, s[40:43], 0 offen offset:256
    buffer_load_dword v109, v30, s[40:43], 0 offen offset:320
    buffer_load_dword v110, v30, s[40:43], 0 offen offset:384
    buffer_load_dword v111, v30, s[40:43], 0 offen offset:448
    v_lshlrev_b32 v32, 2, v4
    v_add3_u32 v32, v32, s55, 24
    v_cmp_gt_u32 vcc, s60, v32
    v_add_lshl_u32 v32, v32, s59, 9
    v_add_u32 v32, v32, v2
    v_cndmask_b32 v31, v33, v32, vcc
    buffer_load_dword v112, v31, s[40:43], 0 offen offset:0
    buffer_load_dword v113, v31, s[40:43], 0 offen offset:64
    buffer_load_dword v114, v31, s[40:43], 0 offen offset:128
    buffer_load_dword v115, v31, s[40:43], 0 offen offset:192
    buffer_load_dword v116, v31, s[40:43], 0 offen offset:256
    buffer_load_dword v117, v31, s[40:43], 0 offen offset:320
    buffer_load_dword v118, v31, s[40:43], 0 offen offset:384
    buffer_load_dword v119, v31, s[40:43], 0 offen offset:448
    s_mov_b32 s99, 1
    s_branch K2_B0
K2_EPI:
    s_cmp_eq_u32 s99, 0
    s_cbranch_scc0 K2_E1
    s_mul_i32 s59, s100, 98
    s_movk_i32 s60, 98
    v_mov_b32 v33, 0x7f000000
    v_lshlrev_b32 v32, 2, v4
    v_add3_u32 v32, v32, s55, 0
    v_cmp_gt_u32 vcc, s60, v32
    v_add_lshl_u32 v32, v32, s59, 9
    v_add_u32 v32, v32, v2
    v_cndmask_b32 v28, v33, v32, vcc
    buffer_load_dword v88, v28, s[40:43], 0 offen offset:0
    buffer_load_dword v89, v28, s[40:43], 0 offen offset:64
    buffer_load_dword v90, v28, s[40:43], 0 offen offset:128
    buffer_load_dword v91, v28, s[40:43], 0 offen offset:192
    buffer_load_dword v92, v28, s[40:43], 0 offen offset:256
    buffer_load_dword v93, v28, s[40:43], 0 offen offset:320
    buffer_load_dword v94, v28, s[40:43], 0 offen offset:384
    buffer_load_dword v95, v28, s[40:43], 0 offen offset:448
    v_lshlrev_b32 v32, 2, v4
    v_add3_u32 v32, v32, s55, 8
    v_cmp_gt_u32 vcc, s60, v32
    v_add_lshl_u32 v32, v32, s59, 9
    v_add_u32 v32, v32, v2
    v_cndmask_b32 v29, v33, v32, vcc
    buffer_load_dword v96, v29, s[40:43], 0 offen offset:0
    buffer_load_dword v97, v29, s[40:43], 0 offen offset:64
    buffer_load_dword v98, v29, s[40:43], 0 offen offset:128
    buffer_load_dword v99, v29, s[40:43], 0 offen offset:192
    buffer_load_dword v100, v29, s[40:43], 0 offen offset:256
    buffer_load_dword v101, v29, s[40:43], 0 offen offset:320
    buffer_load_dword v102, v29, s[40:43], 0 offen offset:384
    buffer_load_dword v103, v29, s[40:43], 0 offen offset:448
    v_lshlrev_b32 v32, 2, v4
    v_add3_u32 v32, v32, s55, 16
    v_cmp_gt_u32 vcc, s60, v32
    v_add_lshl_u32 v32, v32, s59, 9
    v_add_u32 v32, v32, v2
    v_cndmask_b32 v30, v33, v32, vcc
    buffer_load_dword v104, v30, s[40:43], 0 offen offset:0
    buffer_load_dword v105, v30, s[40:43], 0 offen offset:64
    buffer_load_dword v106, v30, s[40:43], 0 offen offset:128
    buffer_load_dword v107, v30, s[40:43], 0 offen offset:192
    buffer_load_dword v108, v30, s[40:43], 0 offen offset:256
    buffer_load_dword v109, v30, s[40:43], 0 offen offset:320
    buffer_load_dword v110, v30, s[40:43], 0 offen offset:384
    buffer_load_dword v111, v30, s[40:43], 0 offen offset:448
    v_lshlrev_b32 v32, 2, v4
    v_add3_u32 v32, v32, s55, 24
    v_cmp_gt_u32 vcc, s60, v32
    v_add_lshl_u32 v32, v32, s59, 9
    v_add_u32 v32, v32, v2
    v_cndmask_b32 v31, v33, v32, vcc
    buffer_load_dword v112, v31, s[40:43], 0 offen offset:0
    buffer_load_dword v113, v31, s[40:43], 0 offen offset:64
    buffer_load_dword v114, v31, s[40:43], 0 offen offset:128
    buffer_load_dword v115, v31, s[40:43], 0 offen offset:192
    buffer_load_dword v116, v31, s[40:43], 0 offen offset:256
    buffer_load_dword v117, v31, s[40:43], 0 offen offset:320
    buffer_load_dword v118, v31, s[40:43], 0 offen offset:384
    buffer_load_dword v119, v31, s[40:43], 0 offen offset:448
    s_mov_b32 s99, 1
K2_E1:
    s_mov_b32 s44, s20
    s_and_b32 s45, s21, 0xffff
    s_mov_b32 s46, 0xc35000
    s_mov_b32 s47, 0x20000
    s_waitcnt vmcnt(0) lgkmcnt(0)
    v_lshlrev_b32 v40, 16, v88
    v_and_b32 v41, s57, v88
    v_lshlrev_b32 v42, 16, v89
    v_and_b32 v43, s57, v89
    v_add_f32 v40, v40, v192
    v_add_f32 v41, v41, v196
    v_add_f32 v42, v42, v200
    v_add_f32 v43, v43, v204
    v_cvt_pk_bf16_f32 v44, v40, v41
    v_cvt_pk_bf16_f32 v45, v42, v43
    buffer_store_dword v44, v28, s[44:47], 0 offen offset:0 sc0 sc1
    buffer_store_dword v45, v28, s[44:47], 0 offen offset:64 sc0 sc1
    v_lshlrev_b32 v48, 16, v90
    v_and_b32 v49, s57, v90
    v_lshlrev_b32 v50, 16, v91
    v_and_b32 v51, s57, v91
    v_add_f32 v48, v48, v208
    v_add_f32 v49, v49, v212
    v_add_f32 v50, v50, v216
    v_add_f32 v51, v51, v220
    v_cvt_pk_bf16_f32 v52, v48, v49
    v_cvt_pk_bf16_f32 v53, v50, v51
    buffer_store_dword v52, v28, s[44:47], 0 offen offset:128 sc0 sc1
    buffer_store_dword v53, v28, s[44:47], 0 offen offset:192 sc0 sc1
    v_lshlrev_b32 v56, 16, v92
    v_and_b32 v57, s57, v92
    v_lshlrev_b32 v58, 16, v93
    v_and_b32 v59, s57, v93
    v_add_f32 v56, v56, v224
    v_add_f32 v57, v57, v228
    v_add_f32 v58, v58, v232
    v_add_f32 v59, v59, v236
    v_cvt_pk_bf16_f32 v60, v56, v57
    v_cvt_pk_bf16_f32 v61, v58, v59
    buffer_store_dword v60, v28, s[44:47], 0 offen offset:256 sc0 sc1
    buffer_store_dword v61, v28, s[44:47], 0 offen offset:320 sc0 sc1
    v_lshlrev_b32 v64, 16, v94
    v_and_b32 v65, s57, v94
    v_lshlrev_b32 v66, 16, v95
    v_and_b32 v67, s57, v95
    v_add_f32 v64, v64, v240
    v_add_f32 v65, v65, v244
    v_add_f32 v66, v66, v248
    v_add_f32 v67, v67, v252
    v_cvt_pk_bf16_f32 v68, v64, v65
    v_cvt_pk_bf16_f32 v69, v66, v67
    buffer_store_dword v68, v28, s[44:47], 0 offen offset:384 sc0 sc1
    buffer_store_dword v69, v28, s[44:47], 0 offen offset:448 sc0 sc1
    v_lshlrev_b32 v40, 16, v96
    v_and_b32 v41, s57, v96
    v_lshlrev_b32 v42, 16, v97
    v_and_b32 v43, s57, v97
    v_add_f32 v40, v40, v193
    v_add_f32 v41, v41, v197
    v_add_f32 v42, v42, v201
    v_add_f32 v43, v43, v205
    v_cvt_pk_bf16_f32 v44, v40, v41
    v_cvt_pk_bf16_f32 v45, v42, v43
    buffer_store_dword v44, v29, s[44:47], 0 offen offset:0 sc0 sc1
    buffer_store_dword v45, v29, s[44:47], 0 offen offset:64 sc0 sc1
    v_lshlrev_b32 v48, 16, v98
    v_and_b32 v49, s57, v98
    v_lshlrev_b32 v50, 16, v99
    v_and_b32 v51, s57, v99
    v_add_f32 v48, v48, v209
    v_add_f32 v49, v49, v213
    v_add_f32 v50, v50, v217
    v_add_f32 v51, v51, v221
    v_cvt_pk_bf16_f32 v52, v48, v49
    v_cvt_pk_bf16_f32 v53, v50, v51
    buffer_store_dword v52, v29, s[44:47], 0 offen offset:128 sc0 sc1
    buffer_store_dword v53, v29, s[44:47], 0 offen offset:192 sc0 sc1
    v_lshlrev_b32 v56, 16, v100
    v_and_b32 v57, s57, v100
    v_lshlrev_b32 v58, 16, v101
    v_and_b32 v59, s57, v101
    v_add_f32 v56, v56, v225
    v_add_f32 v57, v57, v229
    v_add_f32 v58, v58, v233
    v_add_f32 v59, v59, v237
    v_cvt_pk_bf16_f32 v60, v56, v57
    v_cvt_pk_bf16_f32 v61, v58, v59
    buffer_store_dword v60, v29, s[44:47], 0 offen offset:256 sc0 sc1
    buffer_store_dword v61, v29, s[44:47], 0 offen offset:320 sc0 sc1
    v_lshlrev_b32 v64, 16, v102
    v_and_b32 v65, s57, v102
    v_lshlrev_b32 v66, 16, v103
    v_and_b32 v67, s57, v103
    v_add_f32 v64, v64, v241
    v_add_f32 v65, v65, v245
    v_add_f32 v66, v66, v249
    v_add_f32 v67, v67, v253
    v_cvt_pk_bf16_f32 v68, v64, v65
    v_cvt_pk_bf16_f32 v69, v66, v67
    buffer_store_dword v68, v29, s[44:47], 0 offen offset:384 sc0 sc1
    buffer_store_dword v69, v29, s[44:47], 0 offen offset:448 sc0 sc1
    v_lshlrev_b32 v40, 16, v104
    v_and_b32 v41, s57, v104
    v_lshlrev_b32 v42, 16, v105
    v_and_b32 v43, s57, v105
    v_add_f32 v40, v40, v194
    v_add_f32 v41, v41, v198
    v_add_f32 v42, v42, v202
    v_add_f32 v43, v43, v206
    v_cvt_pk_bf16_f32 v44, v40, v41
    v_cvt_pk_bf16_f32 v45, v42, v43
    buffer_store_dword v44, v30, s[44:47], 0 offen offset:0 sc0 sc1
    buffer_store_dword v45, v30, s[44:47], 0 offen offset:64 sc0 sc1
    v_lshlrev_b32 v48, 16, v106
    v_and_b32 v49, s57, v106
    v_lshlrev_b32 v50, 16, v107
    v_and_b32 v51, s57, v107
    v_add_f32 v48, v48, v210
    v_add_f32 v49, v49, v214
    v_add_f32 v50, v50, v218
    v_add_f32 v51, v51, v222
    v_cvt_pk_bf16_f32 v52, v48, v49
    v_cvt_pk_bf16_f32 v53, v50, v51
    buffer_store_dword v52, v30, s[44:47], 0 offen offset:128 sc0 sc1
    buffer_store_dword v53, v30, s[44:47], 0 offen offset:192 sc0 sc1
    v_lshlrev_b32 v56, 16, v108
    v_and_b32 v57, s57, v108
    v_lshlrev_b32 v58, 16, v109
    v_and_b32 v59, s57, v109
    v_add_f32 v56, v56, v226
    v_add_f32 v57, v57, v230
    v_add_f32 v58, v58, v234
    v_add_f32 v59, v59, v238
    v_cvt_pk_bf16_f32 v60, v56, v57
    v_cvt_pk_bf16_f32 v61, v58, v59
    buffer_store_dword v60, v30, s[44:47], 0 offen offset:256 sc0 sc1
    buffer_store_dword v61, v30, s[44:47], 0 offen offset:320 sc0 sc1
    v_lshlrev_b32 v64, 16, v110
    v_and_b32 v65, s57, v110
    v_lshlrev_b32 v66, 16, v111
    v_and_b32 v67, s57, v111
    v_add_f32 v64, v64, v242
    v_add_f32 v65, v65, v246
    v_add_f32 v66, v66, v250
    v_add_f32 v67, v67, v254
    v_cvt_pk_bf16_f32 v68, v64, v65
    v_cvt_pk_bf16_f32 v69, v66, v67
    buffer_store_dword v68, v30, s[44:47], 0 offen offset:384 sc0 sc1
    buffer_store_dword v69, v30, s[44:47], 0 offen offset:448 sc0 sc1
    v_lshlrev_b32 v40, 16, v112
    v_and_b32 v41, s57, v112
    v_lshlrev_b32 v42, 16, v113
    v_and_b32 v43, s57, v113
    v_add_f32 v40, v40, v195
    v_add_f32 v41, v41, v199
    v_add_f32 v42, v42, v203
    v_add_f32 v43, v43, v207
    v_cvt_pk_bf16_f32 v44, v40, v41
    v_cvt_pk_bf16_f32 v45, v42, v43
    buffer_store_dword v44, v31, s[44:47], 0 offen offset:0 sc0 sc1
    buffer_store_dword v45, v31, s[44:47], 0 offen offset:64 sc0 sc1
    v_lshlrev_b32 v48, 16, v114
    v_and_b32 v49, s57, v114
    v_lshlrev_b32 v50, 16, v115
    v_and_b32 v51, s57, v115
    v_add_f32 v48, v48, v211
    v_add_f32 v49, v49, v215
    v_add_f32 v50, v50, v219
    v_add_f32 v51, v51, v223
    v_cvt_pk_bf16_f32 v52, v48, v49
    v_cvt_pk_bf16_f32 v53, v50, v51
    buffer_store_dword v52, v31, s[44:47], 0 offen offset:128 sc0 sc1
    buffer_store_dword v53, v31, s[44:47], 0 offen offset:192 sc0 sc1
    v_lshlrev_b32 v56, 16, v116
    v_and_b32 v57, s57, v116
    v_lshlrev_b32 v58, 16, v117
    v_and_b32 v59, s57, v117
    v_add_f32 v56, v56, v227
    v_add_f32 v57, v57, v231
    v_add_f32 v58, v58, v235
    v_add_f32 v59, v59, v239
    v_cvt_pk_bf16_f32 v60, v56, v57
    v_cvt_pk_bf16_f32 v61, v58, v59
    buffer_store_dword v60, v31, s[44:47], 0 offen offset:256 sc0 sc1
    buffer_store_dword v61, v31, s[44:47], 0 offen offset:320 sc0 sc1
    v_lshlrev_b32 v64, 16, v118
    v_and_b32 v65, s57, v118
    v_lshlrev_b32 v66, 16, v119
    v_and_b32 v67, s57, v119
    v_add_f32 v64, v64, v243
    v_add_f32 v65, v65, v247
    v_add_f32 v66, v66, v251
    v_add_f32 v67, v67, v255
    v_cvt_pk_bf16_f32 v68, v64, v65
    v_cvt_pk_bf16_f32 v69, v66, v67
    buffer_store_dword v68, v31, s[44:47], 0 offen offset:384 sc0 sc1
    buffer_store_dword v69, v31, s[44:47], 0 offen offset:448 sc0 sc1
K_END:
    s_endpgm
.section .rodata,"a"
.p2align 6
.amdhsa_kernel standalone__molecular_angular_painn__graph_kernel
  .amdhsa_next_free_vgpr 256
  .amdhsa_next_free_sgpr 102
  .amdhsa_accum_offset 256
  .amdhsa_group_segment_fixed_size 0
  .amdhsa_kernarg_size 88
  .amdhsa_user_sgpr_count 2
  .amdhsa_user_sgpr_kernarg_segment_ptr 1
  .amdhsa_system_sgpr_workgroup_id_x 1
.end_amdhsa_kernel
```
